```python
import torch

def _softmax(x, axis=-1):
    return torch.softmax(x, dim=axis)
def _gelu(x):
    return torch.nn.functional.gelu(x, approximate="tanh")
def _silu(x):
    return torch.nn.functional.silu(x)
def _sigmoid(x):
    return torch.sigmoid(x)
def _layernorm(x, axis=-1, eps=1e-5):
    m = x.mean(dim=axis, keepdim=True)
    v = x.var(dim=axis, keepdim=True, unbiased=False)
    return (x - m) / torch.sqrt(v + eps)
def _scatter_add(tgt, idx, src, axis=0):
    return tgt.clone().index_add_(axis, idx, src)
def _segment_sum(src, seg, n):
    out = torch.zeros((n,) + src.shape[1:], dtype=src.dtype)
    return out.index_add_(0, seg, src)
def _pad(x, pw):
    flat = tuple(v for pair in reversed(pw) for v in pair)
    return torch.nn.functional.pad(x, flat)

kernel_name = 'sequential_preLN__gqa_block_cached__dense_activation_squared_relu__decode'

def setup_inputs():

    _w = (lambda a: (lambda t: t.to(torch.bfloat16) if t.is_floating_point() else t)(torch.as_tensor(a)))
    def _A_setup():
        B, Sq, D = 8, 1, 448
        Hq, Hkv, Sk, Dh = 16, 8, 4096, 256
        assert Hq % Hkv == 0, (Hq, Hkv)
        return {
            "x": _w((lambda *s: torch.randn(*s, dtype=torch.bfloat16) * 0.05)(B, Sq, D)),
            "k_cache": _w((lambda *s: torch.randn(*s, dtype=torch.bfloat16) * 3.2)(B, Hkv, Sk, Dh)),
            "v_cache": _w((lambda *s: torch.randn(*s, dtype=torch.bfloat16) * 0.4)(B, Hkv, Sk, Dh)),
            "wq": _w((lambda *s: torch.randn(*s, dtype=torch.bfloat16) * 3.2)(D, Hq * Dh) * (D ** -0.5)),
            "wo": _w((lambda *s: torch.randn(*s, dtype=torch.bfloat16) * 0.4)(Hq * Dh, D) * ((Hq * Dh) ** -0.5)),
        }
    _A_in = _A_setup()

    def _B_setup():
        B, S, D, F = 8, 1, 448, 1792
        return {
            "x": _w((lambda *s: torch.randn(*s, dtype=torch.bfloat16) * 0.05)(B, S, D)),
            "w1": _w((lambda *s: torch.randn(*s, dtype=torch.bfloat16) * 0.05)(D, F)),
            "b1": _w((lambda *s: torch.randn(*s, dtype=torch.bfloat16) * 0.8)(F)),
            "w2": _w((lambda *s: torch.randn(*s, dtype=torch.bfloat16) * 0.05)(F, D)),
            "b2": _w((lambda *s: torch.randn(*s, dtype=torch.bfloat16) * 3.2)(D)),
        }
    _B_in = _B_setup()

    return {
        "A_x": _A_in["x"],
        "A_k_cache": _A_in["k_cache"],
        "A_v_cache": _A_in["v_cache"],
        "A_wq": _A_in["wq"],
        "A_wo": _A_in["wo"],
        "B_x": _B_in["x"],
        "B_w1": _B_in["w1"],
        "B_b1": _B_in["b1"],
        "B_w2": _B_in["w2"],
        "B_b2": _B_in["b2"],
    }

def reference(A_x, A_k_cache, A_v_cache, A_wq, A_wo, B_x, B_w1, B_b1, B_w2, B_b2):
    def _A_ref(x, k_cache, v_cache, wq, wo):
        B, Sq, D = x.shape
        Hq, Dh = 16, 256
        Hkv = k_cache.shape[1]
        rep = Hq // Hkv
        q = (lambda x, *d: x.permute(*d))((x @ wq).reshape(B, Sq, Hq, Dh), 0, 2, 1, 3)
        k = (lambda x, n, axis: torch.repeat_interleave(x, n, dim=axis))(k_cache, rep, axis=1)
        v = (lambda x, n, axis: torch.repeat_interleave(x, n, dim=axis))(v_cache, rep, axis=1)
        scores = torch.einsum("bhqd,bhkd->bhqk", q, k) * (Dh ** -0.5)
        p = _softmax(scores, axis=-1)
        o = torch.einsum("bhqk,bhkd->bhqd", p, v)
        return (lambda x, *d: x.permute(*d))(o, 0, 2, 1, 3).reshape(B, Sq, Hq * Dh) @ wo

    def _B_ref(x, w1, b1, w2, b2):
        h = torch.einsum("bsd,df->bsf", x, w1) + b1
        zero = torch.zeros_like(h)
        r = torch.where(h > zero, h, zero)
        h = r * r
        out = torch.einsum("bsf,fd->bsd", h, w2) + b2
        return out

    x = A_x
    h = x + _A_ref(_layernorm(x, axis=-1), A_k_cache, A_v_cache, A_wq, A_wo)
    h2 = h + _B_ref(_layernorm(h, axis=-1), B_w1, B_b1, B_w2, B_b2)
    return h2
```

```asm
; @launch grid=(256,1,1) block=(512,1,1) lds=40960
.amdgcn_target "amdgcn-amd-amdhsa--gfx950"
.text
.globl sequential_preLN__gqa_block_cached__dense_activation_squared_relu__decode_kernel
.p2align 8
.type sequential_preLN__gqa_block_cached__dense_activation_squared_relu__decode_kernel,@function
sequential_preLN__gqa_block_cached__dense_activation_squared_relu__decode_kernel:
    s_cmp_ge_u32 s2, 256
    s_cbranch_scc1 L_end
    s_mov_b32 s99, s2
    s_load_dwordx16 s[8:23], s[0:1], 0
    s_load_dwordx8 s[24:31], s[0:1], 64
    s_load_dwordx2 s[32:33], s[0:1], 96
    v_lshrrev_b32 v1, 6, v0
    v_and_b32 v0, 63, v0
    v_readfirstlane_b32 s3, v1
    s_lshr_b32 s4, s2, 3
    s_lshr_b32 s5, s4, 3
    s_and_b32 s4, s4, 7
    s_lshl_b32 s5, s5, 1
    s_and_b32 s5, s2, 7
    s_lshr_b32 s6, s2, 6
    s_lshl_b32 s7, s4, 3
    s_add_u32 s7, s7, s5
    s_lshl_b32 s34, s6, 3
    s_xor_b32 s35, s5, 4
    s_add_u32 s34, s34, s35
    s_sub_u32 s34, s34, 4
    s_mul_i32 s98, s4, 0
    s_mov_b32 s56, 0x05040100
    s_mov_b32 s57, 0x07060302
    v_and_b32 v2, 15, v0
    v_lshrrev_b32 v3, 4, v0
    s_cmp_ge_u32 s3, 4
    s_cbranch_scc1 L_service
    s_setprio 2
    v_and_b32 v10, 7, v0
    v_lshrrev_b32 v11, 3, v0
    v_lshlrev_b32 v4, 9, v11
    v_lshl_add_u32 v4, v10, 4, v4
    s_lshl_b32 s35, s3, 12
    v_add_u32 v4, s35, v4
    v_lshlrev_b32 v5, 4, v0
    s_lshl_b32 s35, s3, 13
    v_add_u32 v5, s35, v5
    s_lshl_b32 s35, s7, 21
    s_lshl_b32 s36, s6, 19
    s_add_u32 s35, s35, s36
    s_waitcnt lgkmcnt(0)
    s_add_u32 s36, s10, s35
    s_addc_u32 s37, s11, 0
    s_mov_b32 s38, 524288
    s_mov_b32 s39, 0x20000
    s_add_u32 s40, s12, s35
    s_addc_u32 s41, s13, 0
    s_mov_b32 s42, 524288
    s_mov_b32 s43, 0x20000
    s_mov_b32 s44, s24
    s_mov_b32 s45, s25
    s_mov_b32 s46, 1605632
    s_mov_b32 s47, 0x20000
    s_mov_b32 s48, 0
    buffer_load_dwordx4 v[88:91], v4, s[36:39], s48 offen offset:0 nt
    buffer_load_dwordx4 v[92:95], v4, s[36:39], s48 offen offset:128 nt
    buffer_load_dwordx4 v[96:99], v4, s[36:39], s48 offen offset:256 nt
    buffer_load_dwordx4 v[100:103], v4, s[36:39], s48 offen offset:384 nt
    s_mov_b32 s48, 16384
    buffer_load_dwordx4 v[104:107], v4, s[36:39], s48 offen offset:0 nt
    buffer_load_dwordx4 v[108:111], v4, s[36:39], s48 offen offset:128 nt
    s_lshl_b32 s35, s3, 5
    v_lshrrev_b32 v10, 3, v0
    v_lshl_add_u32 v6, v10, 2, s35
    v_lshrrev_b32 v10, 2, v2
    v_and_b32 v11, 1, v10
    v_lshrrev_b32 v12, 1, v10
    v_and_b32 v13, 1, v3
    v_lshrrev_b32 v14, 1, v3
    v_lshlrev_b32 v11, 5, v11
    v_lshl_add_u32 v11, v14, 4, v11
    s_lshl_b32 s35, s3, 6
    s_add_u32 s35, s35, 16384
    v_add_u32 v11, s35, v11
    v_mov_b32 v10, 20480
    v_cmp_eq_u32 vcc, v12, v13
    s_nop 1
    v_cndmask_b32 v7, v10, v11, vcc
    v_mov_b32 v8, 40448
    v_mul_u32_u24 v9, 7168, v3
    v_lshl_add_u32 v9, v2, 4, v9
    s_lshl_b32 s35, s3, 8
    v_add_u32 v9, s35, v9
    s_max_i32 s49, s34, 0
    s_mul_i32 s49, s49, 57344
    s_mov_b64 s[52:53], -1
    s_cmp_eq_u32 s3, 3
    s_cselect_b32 s52, 0x00ff00ff, s52
    s_cselect_b32 s53, 0x00ff00ff, s53
    s_cmp_lt_i32 s34, 0
    s_cselect_b32 s46, 0, s46
    v_and_b32 v10, 7, v0
    v_lshlrev_b32 v15, 4, v10
    s_barrier
    s_waitcnt vmcnt(5)
    buffer_load_dwordx4 v[112:115], v4, s[36:39], s48 offen offset:256 nt
    s_waitcnt vmcnt(5)
    buffer_load_dwordx4 v[116:119], v4, s[36:39], s48 offen offset:384 nt
    s_waitcnt vmcnt(5)
    s_mov_b32 s48, 32768
    buffer_load_dwordx4 v[120:123], v4, s[36:39], s48 offen offset:0 nt
    s_waitcnt vmcnt(5)
    buffer_load_dwordx4 v[124:127], v4, s[36:39], s48 offen offset:128 nt
    s_waitcnt vmcnt(5)
    buffer_load_dwordx4 v[128:131], v4, s[36:39], s48 offen offset:256 nt
    s_waitcnt vmcnt(5)
    buffer_load_dwordx4 v[132:135], v4, s[36:39], s48 offen offset:384 nt
    s_waitcnt vmcnt(5)
    s_mov_b32 s48, 49152
    buffer_load_dwordx4 v[136:139], v4, s[36:39], s48 offen offset:0 nt
    s_waitcnt vmcnt(5)
    buffer_load_dwordx4 v[140:143], v4, s[36:39], s48 offen offset:128 nt
    s_waitcnt vmcnt(5)
    buffer_load_dwordx4 v[144:147], v4, s[36:39], s48 offen offset:256 nt
    s_waitcnt vmcnt(5)
    buffer_load_dwordx4 v[148:151], v4, s[36:39], s48 offen offset:384 nt
    s_waitcnt vmcnt(5)
    s_mov_b32 s48, 65536
    buffer_load_dwordx4 v[152:155], v4, s[36:39], s48 offen offset:0 nt
    s_waitcnt vmcnt(5)
    buffer_load_dwordx4 v[156:159], v4, s[36:39], s48 offen offset:128 nt
    s_waitcnt vmcnt(5)
    buffer_load_dwordx4 v[160:163], v4, s[36:39], s48 offen offset:256 nt
    s_waitcnt vmcnt(5)
    buffer_load_dwordx4 v[164:167], v4, s[36:39], s48 offen offset:384 nt
    s_waitcnt vmcnt(5)
    s_mov_b32 s48, 81920
    buffer_load_dwordx4 v[168:171], v4, s[36:39], s48 offen offset:0 nt
    s_waitcnt vmcnt(5)
    buffer_load_dwordx4 v[172:175], v4, s[36:39], s48 offen offset:128 nt
    s_waitcnt vmcnt(5)
    buffer_load_dwordx4 v[176:179], v4, s[36:39], s48 offen offset:256 nt
    s_waitcnt vmcnt(5)
    buffer_load_dwordx4 v[180:183], v4, s[36:39], s48 offen offset:384 nt
    s_waitcnt vmcnt(5)
    s_mov_b32 s48, 98304
    buffer_load_dwordx4 v[184:187], v4, s[36:39], s48 offen offset:0 nt
    s_waitcnt vmcnt(5)
    buffer_load_dwordx4 v[188:191], v4, s[36:39], s48 offen offset:128 nt
    s_waitcnt vmcnt(5)
    buffer_load_dwordx4 v[192:195], v4, s[36:39], s48 offen offset:256 nt
    s_waitcnt vmcnt(5)
    buffer_load_dwordx4 v[196:199], v4, s[36:39], s48 offen offset:384 nt
    s_waitcnt vmcnt(5)
    s_mov_b32 s48, 114688
    buffer_load_dwordx4 v[200:203], v4, s[36:39], s48 offen offset:0 nt
    v_mov_b32 v10, 1
    ds_write_b32 v8, v10 offset:16
    s_waitcnt vmcnt(5)
    buffer_load_dwordx4 v[204:207], v4, s[36:39], s48 offen offset:128 nt
    s_waitcnt vmcnt(5)
    buffer_load_dwordx4 v[208:211], v4, s[36:39], s48 offen offset:256 nt
    s_waitcnt vmcnt(5)
    buffer_load_dwordx4 v[212:215], v4, s[36:39], s48 offen offset:384 nt
    s_waitcnt vmcnt(5)
    s_mov_b32 s48, 131072
    buffer_load_dwordx4 v[216:219], v4, s[36:39], s48 offen offset:0 nt
    s_waitcnt vmcnt(5)
    buffer_load_dwordx4 v[220:223], v4, s[36:39], s48 offen offset:128 nt
    s_waitcnt vmcnt(5)
    buffer_load_dwordx4 v[224:227], v4, s[36:39], s48 offen offset:256 nt
    s_waitcnt vmcnt(5)
    buffer_load_dwordx4 v[228:231], v4, s[36:39], s48 offen offset:384 nt
    s_waitcnt vmcnt(5)
    s_mov_b32 s48, 147456
    buffer_load_dwordx4 v[232:235], v4, s[36:39], s48 offen offset:0 nt
    s_waitcnt vmcnt(5)
    buffer_load_dwordx4 v[236:239], v4, s[36:39], s48 offen offset:128 nt
    s_waitcnt vmcnt(5)
    buffer_load_dwordx4 v[240:243], v4, s[36:39], s48 offen offset:256 nt
    s_waitcnt vmcnt(5)
    buffer_load_dwordx4 v[244:247], v4, s[36:39], s48 offen offset:384 nt
    s_waitcnt vmcnt(5)
    s_mov_b32 s48, 163840
    buffer_load_dwordx4 v[248:251], v4, s[36:39], s48 offen offset:0 nt
    s_waitcnt vmcnt(5)
    buffer_load_dwordx4 v[252:255], v4, s[36:39], s48 offen offset:128 nt
    s_mov_b32 s59, 800000
L_spin_1:
    ds_read_b32 v10, v8 offset:4
    s_waitcnt lgkmcnt(0)
    v_readfirstlane_b32 s50, v10
    s_nop 0
    s_cmp_eq_u32 s50, 1
    s_cbranch_scc1 L_spun_2
    s_sleep 1
    s_sub_u32 s59, s59, 1
    s_cmp_lg_u32 s59, 0
    s_cbranch_scc1 L_spin_1
L_spun_2:
    ds_read_b128 v[16:19], v15 offset:7168
    ds_read_b128 v[20:23], v15 offset:7680
    ds_read_b128 v[24:27], v15 offset:7296
    ds_read_b128 v[28:31], v15 offset:7808
    ds_read_b128 v[32:35], v15 offset:7424
    ds_read_b128 v[36:39], v15 offset:7936
    ds_read_b128 v[40:43], v15 offset:7552
    ds_read_b128 v[44:47], v15 offset:8064
    s_waitcnt lgkmcnt(0)
    v_dot2_f32_bf16 v48, v88, v16, 0
    v_dot2_f32_bf16 v49, v88, v20, 0
    v_dot2_f32_bf16 v48, v89, v17, v48
    v_dot2_f32_bf16 v49, v89, v21, v49
    v_dot2_f32_bf16 v48, v90, v18, v48
    v_dot2_f32_bf16 v49, v90, v22, v49
    v_dot2_f32_bf16 v48, v91, v19, v48
    v_dot2_f32_bf16 v49, v91, v23, v49
    s_waitcnt vmcnt(5)
    buffer_load_dwordx4 v[88:91], v4, s[36:39], s48 offen offset:256 nt
    v_dot2_f32_bf16 v48, v92, v24, v48
    v_dot2_f32_bf16 v49, v92, v28, v49
    v_dot2_f32_bf16 v48, v93, v25, v48
    v_dot2_f32_bf16 v49, v93, v29, v49
    v_dot2_f32_bf16 v48, v94, v26, v48
    v_dot2_f32_bf16 v49, v94, v30, v49
    v_dot2_f32_bf16 v48, v95, v27, v48
    v_dot2_f32_bf16 v49, v95, v31, v49
    s_waitcnt vmcnt(5)
    buffer_load_dwordx4 v[92:95], v4, s[36:39], s48 offen offset:384 nt
    v_dot2_f32_bf16 v48, v96, v32, v48
    v_dot2_f32_bf16 v49, v96, v36, v49
    v_dot2_f32_bf16 v48, v97, v33, v48
    v_dot2_f32_bf16 v49, v97, v37, v49
    v_dot2_f32_bf16 v48, v98, v34, v48
    v_dot2_f32_bf16 v49, v98, v38, v49
    v_dot2_f32_bf16 v48, v99, v35, v48
    v_dot2_f32_bf16 v49, v99, v39, v49
    s_waitcnt vmcnt(5)
    s_mov_b32 s48, 180224
    buffer_load_dwordx4 v[96:99], v4, s[36:39], s48 offen offset:0 nt
    v_dot2_f32_bf16 v48, v100, v40, v48
    v_dot2_f32_bf16 v49, v100, v44, v49
    v_dot2_f32_bf16 v48, v101, v41, v48
    v_dot2_f32_bf16 v49, v101, v45, v49
    v_dot2_f32_bf16 v48, v102, v42, v48
    v_dot2_f32_bf16 v49, v102, v46, v49
    v_dot2_f32_bf16 v48, v103, v43, v48
    v_dot2_f32_bf16 v49, v103, v47, v49
    s_waitcnt vmcnt(5)
    buffer_load_dwordx4 v[100:103], v4, s[36:39], s48 offen offset:128 nt
    v_dot2_f32_bf16 v50, v104, v16, 0
    v_dot2_f32_bf16 v51, v104, v20, 0
    v_dot2_f32_bf16 v50, v105, v17, v50
    v_dot2_f32_bf16 v51, v105, v21, v51
    v_dot2_f32_bf16 v50, v106, v18, v50
    v_dot2_f32_bf16 v51, v106, v22, v51
    v_dot2_f32_bf16 v50, v107, v19, v50
    v_dot2_f32_bf16 v51, v107, v23, v51
    v_add_f32_dpp v48, v48, v48 quad_perm:[1,0,3,2] row_mask:0xf bank_mask:0xf
    v_add_f32_dpp v49, v49, v49 quad_perm:[1,0,3,2] row_mask:0xf bank_mask:0xf
    s_nop 0
    v_add_f32_dpp v48, v48, v48 quad_perm:[2,3,0,1] row_mask:0xf bank_mask:0xf
    v_add_f32_dpp v49, v49, v49 quad_perm:[2,3,0,1] row_mask:0xf bank_mask:0xf
    s_nop 0
    v_add_f32_dpp v48, v48, v48 row_half_mirror row_mask:0xf bank_mask:0xf
    v_add_f32_dpp v49, v49, v49 row_half_mirror row_mask:0xf bank_mask:0xf
    s_nop 0
    v_cvt_pk_bf16_f32 v10, v48, v49
    ds_write_b32 v6, v10 offset:8192
    v_dot2_f32_bf16 v50, v108, v24, v50
    v_dot2_f32_bf16 v51, v108, v28, v51
    v_dot2_f32_bf16 v50, v109, v25, v50
    v_dot2_f32_bf16 v51, v109, v29, v51
    v_dot2_f32_bf16 v50, v110, v26, v50
    v_dot2_f32_bf16 v51, v110, v30, v51
    v_dot2_f32_bf16 v50, v111, v27, v50
    v_dot2_f32_bf16 v51, v111, v31, v51
    v_dot2_f32_bf16 v50, v112, v32, v50
    v_dot2_f32_bf16 v51, v112, v36, v51
    v_dot2_f32_bf16 v50, v113, v33, v50
    v_dot2_f32_bf16 v51, v113, v37, v51
    v_dot2_f32_bf16 v50, v114, v34, v50
    v_dot2_f32_bf16 v51, v114, v38, v51
    v_dot2_f32_bf16 v50, v115, v35, v50
    v_dot2_f32_bf16 v51, v115, v39, v51
    s_waitcnt vmcnt(5)
    buffer_load_dwordx4 v[104:107], v4, s[36:39], s48 offen offset:256 nt
    v_dot2_f32_bf16 v50, v116, v40, v50
    v_dot2_f32_bf16 v51, v116, v44, v51
    v_dot2_f32_bf16 v50, v117, v41, v50
    v_dot2_f32_bf16 v51, v117, v45, v51
    v_dot2_f32_bf16 v50, v118, v42, v50
    v_dot2_f32_bf16 v51, v118, v46, v51
    v_dot2_f32_bf16 v50, v119, v43, v50
    v_dot2_f32_bf16 v51, v119, v47, v51
    v_dot2_f32_bf16 v48, v120, v16, 0
    v_dot2_f32_bf16 v49, v120, v20, 0
    v_dot2_f32_bf16 v48, v121, v17, v48
    v_dot2_f32_bf16 v49, v121, v21, v49
    v_dot2_f32_bf16 v48, v122, v18, v48
    v_dot2_f32_bf16 v49, v122, v22, v49
    v_dot2_f32_bf16 v48, v123, v19, v48
    v_dot2_f32_bf16 v49, v123, v23, v49
    v_add_f32_dpp v50, v50, v50 quad_perm:[1,0,3,2] row_mask:0xf bank_mask:0xf
    v_add_f32_dpp v51, v51, v51 quad_perm:[1,0,3,2] row_mask:0xf bank_mask:0xf
    s_nop 0
    v_add_f32_dpp v50, v50, v50 quad_perm:[2,3,0,1] row_mask:0xf bank_mask:0xf
    v_add_f32_dpp v51, v51, v51 quad_perm:[2,3,0,1] row_mask:0xf bank_mask:0xf
    s_nop 0
    v_add_f32_dpp v50, v50, v50 row_half_mirror row_mask:0xf bank_mask:0xf
    v_add_f32_dpp v51, v51, v51 row_half_mirror row_mask:0xf bank_mask:0xf
    s_nop 0
    v_cvt_pk_bf16_f32 v10, v50, v51
    ds_write_b32 v6, v10 offset:8320
    v_dot2_f32_bf16 v48, v124, v24, v48
    v_dot2_f32_bf16 v49, v124, v28, v49
    v_dot2_f32_bf16 v48, v125, v25, v48
    v_dot2_f32_bf16 v49, v125, v29, v49
    v_dot2_f32_bf16 v48, v126, v26, v48
    v_dot2_f32_bf16 v49, v126, v30, v49
    v_dot2_f32_bf16 v48, v127, v27, v48
    v_dot2_f32_bf16 v49, v127, v31, v49
    s_waitcnt vmcnt(5)
    buffer_load_dwordx4 v[108:111], v4, s[36:39], s48 offen offset:384 nt
    v_dot2_f32_bf16 v48, v128, v32, v48
    v_dot2_f32_bf16 v49, v128, v36, v49
    v_dot2_f32_bf16 v48, v129, v33, v48
    v_dot2_f32_bf16 v49, v129, v37, v49
    v_dot2_f32_bf16 v48, v130, v34, v48
    v_dot2_f32_bf16 v49, v130, v38, v49
    v_dot2_f32_bf16 v48, v131, v35, v48
    v_dot2_f32_bf16 v49, v131, v39, v49
    v_dot2_f32_bf16 v48, v132, v40, v48
    v_dot2_f32_bf16 v49, v132, v44, v49
    v_dot2_f32_bf16 v48, v133, v41, v48
    v_dot2_f32_bf16 v49, v133, v45, v49
    v_dot2_f32_bf16 v48, v134, v42, v48
    v_dot2_f32_bf16 v49, v134, v46, v49
    v_dot2_f32_bf16 v48, v135, v43, v48
    v_dot2_f32_bf16 v49, v135, v47, v49
    v_dot2_f32_bf16 v50, v136, v16, 0
    v_dot2_f32_bf16 v51, v136, v20, 0
    v_dot2_f32_bf16 v50, v137, v17, v50
    v_dot2_f32_bf16 v51, v137, v21, v51
    v_dot2_f32_bf16 v50, v138, v18, v50
    v_dot2_f32_bf16 v51, v138, v22, v51
    v_dot2_f32_bf16 v50, v139, v19, v50
    v_dot2_f32_bf16 v51, v139, v23, v51
    v_add_f32_dpp v48, v48, v48 quad_perm:[1,0,3,2] row_mask:0xf bank_mask:0xf
    v_add_f32_dpp v49, v49, v49 quad_perm:[1,0,3,2] row_mask:0xf bank_mask:0xf
    s_nop 0
    v_add_f32_dpp v48, v48, v48 quad_perm:[2,3,0,1] row_mask:0xf bank_mask:0xf
    v_add_f32_dpp v49, v49, v49 quad_perm:[2,3,0,1] row_mask:0xf bank_mask:0xf
    s_nop 0
    v_add_f32_dpp v48, v48, v48 row_half_mirror row_mask:0xf bank_mask:0xf
    v_add_f32_dpp v49, v49, v49 row_half_mirror row_mask:0xf bank_mask:0xf
    s_nop 0
    v_cvt_pk_bf16_f32 v10, v48, v49
    ds_write_b32 v6, v10 offset:8448
    s_waitcnt vmcnt(5)
    s_mov_b32 s48, 196608
    buffer_load_dwordx4 v[112:115], v4, s[36:39], s48 offen offset:0 nt
    v_dot2_f32_bf16 v50, v140, v24, v50
    v_dot2_f32_bf16 v51, v140, v28, v51
    v_dot2_f32_bf16 v50, v141, v25, v50
    v_dot2_f32_bf16 v51, v141, v29, v51
    v_dot2_f32_bf16 v50, v142, v26, v50
    v_dot2_f32_bf16 v51, v142, v30, v51
    v_dot2_f32_bf16 v50, v143, v27, v50
    v_dot2_f32_bf16 v51, v143, v31, v51
    v_dot2_f32_bf16 v50, v144, v32, v50
    v_dot2_f32_bf16 v51, v144, v36, v51
    v_dot2_f32_bf16 v50, v145, v33, v50
    v_dot2_f32_bf16 v51, v145, v37, v51
    v_dot2_f32_bf16 v50, v146, v34, v50
    v_dot2_f32_bf16 v51, v146, v38, v51
    v_dot2_f32_bf16 v50, v147, v35, v50
    v_dot2_f32_bf16 v51, v147, v39, v51
    v_dot2_f32_bf16 v50, v148, v40, v50
    v_dot2_f32_bf16 v51, v148, v44, v51
    v_dot2_f32_bf16 v50, v149, v41, v50
    v_dot2_f32_bf16 v51, v149, v45, v51
    v_dot2_f32_bf16 v50, v150, v42, v50
    v_dot2_f32_bf16 v51, v150, v46, v51
    v_dot2_f32_bf16 v50, v151, v43, v50
    v_dot2_f32_bf16 v51, v151, v47, v51
    s_waitcnt vmcnt(5)
    buffer_load_dwordx4 v[116:119], v4, s[36:39], s48 offen offset:128 nt
    v_dot2_f32_bf16 v48, v152, v16, 0
    v_dot2_f32_bf16 v49, v152, v20, 0
    v_dot2_f32_bf16 v48, v153, v17, v48
    v_dot2_f32_bf16 v49, v153, v21, v49
    v_dot2_f32_bf16 v48, v154, v18, v48
    v_dot2_f32_bf16 v49, v154, v22, v49
    v_dot2_f32_bf16 v48, v155, v19, v48
    v_dot2_f32_bf16 v49, v155, v23, v49
    v_add_f32_dpp v50, v50, v50 quad_perm:[1,0,3,2] row_mask:0xf bank_mask:0xf
    v_add_f32_dpp v51, v51, v51 quad_perm:[1,0,3,2] row_mask:0xf bank_mask:0xf
    s_nop 0
    v_add_f32_dpp v50, v50, v50 quad_perm:[2,3,0,1] row_mask:0xf bank_mask:0xf
    v_add_f32_dpp v51, v51, v51 quad_perm:[2,3,0,1] row_mask:0xf bank_mask:0xf
    s_nop 0
    v_add_f32_dpp v50, v50, v50 row_half_mirror row_mask:0xf bank_mask:0xf
    v_add_f32_dpp v51, v51, v51 row_half_mirror row_mask:0xf bank_mask:0xf
    s_nop 0
    v_cvt_pk_bf16_f32 v10, v50, v51
    ds_write_b32 v6, v10 offset:8576
    v_dot2_f32_bf16 v48, v156, v24, v48
    v_dot2_f32_bf16 v49, v156, v28, v49
    v_dot2_f32_bf16 v48, v157, v25, v48
    v_dot2_f32_bf16 v49, v157, v29, v49
    v_dot2_f32_bf16 v48, v158, v26, v48
    v_dot2_f32_bf16 v49, v158, v30, v49
    v_dot2_f32_bf16 v48, v159, v27, v48
    v_dot2_f32_bf16 v49, v159, v31, v49
    v_dot2_f32_bf16 v48, v160, v32, v48
    v_dot2_f32_bf16 v49, v160, v36, v49
    v_dot2_f32_bf16 v48, v161, v33, v48
    v_dot2_f32_bf16 v49, v161, v37, v49
    v_dot2_f32_bf16 v48, v162, v34, v48
    v_dot2_f32_bf16 v49, v162, v38, v49
    v_dot2_f32_bf16 v48, v163, v35, v48
    v_dot2_f32_bf16 v49, v163, v39, v49
    s_waitcnt vmcnt(5)
    buffer_load_dwordx4 v[120:123], v4, s[36:39], s48 offen offset:256 nt
    v_dot2_f32_bf16 v48, v164, v40, v48
    v_dot2_f32_bf16 v49, v164, v44, v49
    v_dot2_f32_bf16 v48, v165, v41, v48
    v_dot2_f32_bf16 v49, v165, v45, v49
    v_dot2_f32_bf16 v48, v166, v42, v48
    v_dot2_f32_bf16 v49, v166, v46, v49
    v_dot2_f32_bf16 v48, v167, v43, v48
    v_dot2_f32_bf16 v49, v167, v47, v49
    v_dot2_f32_bf16 v50, v168, v16, 0
    v_dot2_f32_bf16 v51, v168, v20, 0
    v_dot2_f32_bf16 v50, v169, v17, v50
    v_dot2_f32_bf16 v51, v169, v21, v51
    v_dot2_f32_bf16 v50, v170, v18, v50
    v_dot2_f32_bf16 v51, v170, v22, v51
    v_dot2_f32_bf16 v50, v171, v19, v50
    v_dot2_f32_bf16 v51, v171, v23, v51
    v_add_f32_dpp v48, v48, v48 quad_perm:[1,0,3,2] row_mask:0xf bank_mask:0xf
    v_add_f32_dpp v49, v49, v49 quad_perm:[1,0,3,2] row_mask:0xf bank_mask:0xf
    s_nop 0
    v_add_f32_dpp v48, v48, v48 quad_perm:[2,3,0,1] row_mask:0xf bank_mask:0xf
    v_add_f32_dpp v49, v49, v49 quad_perm:[2,3,0,1] row_mask:0xf bank_mask:0xf
    s_nop 0
    v_add_f32_dpp v48, v48, v48 row_half_mirror row_mask:0xf bank_mask:0xf
    v_add_f32_dpp v49, v49, v49 row_half_mirror row_mask:0xf bank_mask:0xf
    s_nop 0
    v_cvt_pk_bf16_f32 v10, v48, v49
    ds_write_b32 v6, v10 offset:8704
    v_dot2_f32_bf16 v50, v172, v24, v50
    v_dot2_f32_bf16 v51, v172, v28, v51
    v_dot2_f32_bf16 v50, v173, v25, v50
    v_dot2_f32_bf16 v51, v173, v29, v51
    v_dot2_f32_bf16 v50, v174, v26, v50
    v_dot2_f32_bf16 v51, v174, v30, v51
    v_dot2_f32_bf16 v50, v175, v27, v50
    v_dot2_f32_bf16 v51, v175, v31, v51
    s_waitcnt vmcnt(5)
    buffer_load_dwordx4 v[124:127], v4, s[36:39], s48 offen offset:384 nt
    v_dot2_f32_bf16 v50, v176, v32, v50
    v_dot2_f32_bf16 v51, v176, v36, v51
    v_dot2_f32_bf16 v50, v177, v33, v50
    v_dot2_f32_bf16 v51, v177, v37, v51
    v_dot2_f32_bf16 v50, v178, v34, v50
    v_dot2_f32_bf16 v51, v178, v38, v51
    v_dot2_f32_bf16 v50, v179, v35, v50
    v_dot2_f32_bf16 v51, v179, v39, v51
    v_dot2_f32_bf16 v50, v180, v40, v50
    v_dot2_f32_bf16 v51, v180, v44, v51
    v_dot2_f32_bf16 v50, v181, v41, v50
    v_dot2_f32_bf16 v51, v181, v45, v51
    v_dot2_f32_bf16 v50, v182, v42, v50
    v_dot2_f32_bf16 v51, v182, v46, v51
    v_dot2_f32_bf16 v50, v183, v43, v50
    v_dot2_f32_bf16 v51, v183, v47, v51
    v_dot2_f32_bf16 v48, v184, v16, 0
    v_dot2_f32_bf16 v49, v184, v20, 0
    v_dot2_f32_bf16 v48, v185, v17, v48
    v_dot2_f32_bf16 v49, v185, v21, v49
    v_dot2_f32_bf16 v48, v186, v18, v48
    v_dot2_f32_bf16 v49, v186, v22, v49
    v_dot2_f32_bf16 v48, v187, v19, v48
    v_dot2_f32_bf16 v49, v187, v23, v49
    v_add_f32_dpp v50, v50, v50 quad_perm:[1,0,3,2] row_mask:0xf bank_mask:0xf
    v_add_f32_dpp v51, v51, v51 quad_perm:[1,0,3,2] row_mask:0xf bank_mask:0xf
    s_nop 0
    v_add_f32_dpp v50, v50, v50 quad_perm:[2,3,0,1] row_mask:0xf bank_mask:0xf
    v_add_f32_dpp v51, v51, v51 quad_perm:[2,3,0,1] row_mask:0xf bank_mask:0xf
    s_nop 0
    v_add_f32_dpp v50, v50, v50 row_half_mirror row_mask:0xf bank_mask:0xf
    v_add_f32_dpp v51, v51, v51 row_half_mirror row_mask:0xf bank_mask:0xf
    s_nop 0
    v_cvt_pk_bf16_f32 v10, v50, v51
    ds_write_b32 v6, v10 offset:8832
    s_waitcnt vmcnt(5)
    s_mov_b32 s48, 212992
    buffer_load_dwordx4 v[128:131], v4, s[36:39], s48 offen offset:0 nt
    v_dot2_f32_bf16 v48, v188, v24, v48
    v_dot2_f32_bf16 v49, v188, v28, v49
    v_dot2_f32_bf16 v48, v189, v25, v48
    v_dot2_f32_bf16 v49, v189, v29, v49
    v_dot2_f32_bf16 v48, v190, v26, v48
    v_dot2_f32_bf16 v49, v190, v30, v49
    v_dot2_f32_bf16 v48, v191, v27, v48
    v_dot2_f32_bf16 v49, v191, v31, v49
    v_dot2_f32_bf16 v48, v192, v32, v48
    v_dot2_f32_bf16 v49, v192, v36, v49
    v_dot2_f32_bf16 v48, v193, v33, v48
    v_dot2_f32_bf16 v49, v193, v37, v49
    v_dot2_f32_bf16 v48, v194, v34, v48
    v_dot2_f32_bf16 v49, v194, v38, v49
    v_dot2_f32_bf16 v48, v195, v35, v48
    v_dot2_f32_bf16 v49, v195, v39, v49
    v_dot2_f32_bf16 v48, v196, v40, v48
    v_dot2_f32_bf16 v49, v196, v44, v49
    v_dot2_f32_bf16 v48, v197, v41, v48
    v_dot2_f32_bf16 v49, v197, v45, v49
    v_dot2_f32_bf16 v48, v198, v42, v48
    v_dot2_f32_bf16 v49, v198, v46, v49
    v_dot2_f32_bf16 v48, v199, v43, v48
    v_dot2_f32_bf16 v49, v199, v47, v49
    s_waitcnt vmcnt(5)
    buffer_load_dwordx4 v[132:135], v4, s[36:39], s48 offen offset:128 nt
    v_dot2_f32_bf16 v50, v200, v16, 0
    v_dot2_f32_bf16 v51, v200, v20, 0
    v_dot2_f32_bf16 v50, v201, v17, v50
    v_dot2_f32_bf16 v51, v201, v21, v51
    v_dot2_f32_bf16 v50, v202, v18, v50
    v_dot2_f32_bf16 v51, v202, v22, v51
    v_dot2_f32_bf16 v50, v203, v19, v50
    v_dot2_f32_bf16 v51, v203, v23, v51
    v_add_f32_dpp v48, v48, v48 quad_perm:[1,0,3,2] row_mask:0xf bank_mask:0xf
    v_add_f32_dpp v49, v49, v49 quad_perm:[1,0,3,2] row_mask:0xf bank_mask:0xf
    s_nop 0
    v_add_f32_dpp v48, v48, v48 quad_perm:[2,3,0,1] row_mask:0xf bank_mask:0xf
    v_add_f32_dpp v49, v49, v49 quad_perm:[2,3,0,1] row_mask:0xf bank_mask:0xf
    s_nop 0
    v_add_f32_dpp v48, v48, v48 row_half_mirror row_mask:0xf bank_mask:0xf
    v_add_f32_dpp v49, v49, v49 row_half_mirror row_mask:0xf bank_mask:0xf
    s_nop 0
    v_cvt_pk_bf16_f32 v10, v48, v49
    ds_write_b32 v6, v10 offset:8960
    v_dot2_f32_bf16 v50, v204, v24, v50
    v_dot2_f32_bf16 v51, v204, v28, v51
    v_dot2_f32_bf16 v50, v205, v25, v50
    v_dot2_f32_bf16 v51, v205, v29, v51
    v_dot2_f32_bf16 v50, v206, v26, v50
    v_dot2_f32_bf16 v51, v206, v30, v51
    v_dot2_f32_bf16 v50, v207, v27, v50
    v_dot2_f32_bf16 v51, v207, v31, v51
    v_dot2_f32_bf16 v50, v208, v32, v50
    v_dot2_f32_bf16 v51, v208, v36, v51
    v_dot2_f32_bf16 v50, v209, v33, v50
    v_dot2_f32_bf16 v51, v209, v37, v51
    v_dot2_f32_bf16 v50, v210, v34, v50
    v_dot2_f32_bf16 v51, v210, v38, v51
    v_dot2_f32_bf16 v50, v211, v35, v50
    v_dot2_f32_bf16 v51, v211, v39, v51
    s_waitcnt vmcnt(5)
    buffer_load_dwordx4 v[136:139], v4, s[36:39], s48 offen offset:256 nt
    v_dot2_f32_bf16 v50, v212, v40, v50
    v_dot2_f32_bf16 v51, v212, v44, v51
    v_dot2_f32_bf16 v50, v213, v41, v50
    v_dot2_f32_bf16 v51, v213, v45, v51
    v_dot2_f32_bf16 v50, v214, v42, v50
    v_dot2_f32_bf16 v51, v214, v46, v51
    v_dot2_f32_bf16 v50, v215, v43, v50
    v_dot2_f32_bf16 v51, v215, v47, v51
    v_dot2_f32_bf16 v48, v216, v16, 0
    v_dot2_f32_bf16 v49, v216, v20, 0
    v_dot2_f32_bf16 v48, v217, v17, v48
    v_dot2_f32_bf16 v49, v217, v21, v49
    v_dot2_f32_bf16 v48, v218, v18, v48
    v_dot2_f32_bf16 v49, v218, v22, v49
    v_dot2_f32_bf16 v48, v219, v19, v48
    v_dot2_f32_bf16 v49, v219, v23, v49
    v_add_f32_dpp v50, v50, v50 quad_perm:[1,0,3,2] row_mask:0xf bank_mask:0xf
    v_add_f32_dpp v51, v51, v51 quad_perm:[1,0,3,2] row_mask:0xf bank_mask:0xf
    s_nop 0
    v_add_f32_dpp v50, v50, v50 quad_perm:[2,3,0,1] row_mask:0xf bank_mask:0xf
    v_add_f32_dpp v51, v51, v51 quad_perm:[2,3,0,1] row_mask:0xf bank_mask:0xf
    s_nop 0
    v_add_f32_dpp v50, v50, v50 row_half_mirror row_mask:0xf bank_mask:0xf
    v_add_f32_dpp v51, v51, v51 row_half_mirror row_mask:0xf bank_mask:0xf
    s_nop 0
    v_cvt_pk_bf16_f32 v10, v50, v51
    ds_write_b32 v6, v10 offset:9088
    v_dot2_f32_bf16 v48, v220, v24, v48
    v_dot2_f32_bf16 v49, v220, v28, v49
    v_dot2_f32_bf16 v48, v221, v25, v48
    v_dot2_f32_bf16 v49, v221, v29, v49
    v_dot2_f32_bf16 v48, v222, v26, v48
    v_dot2_f32_bf16 v49, v222, v30, v49
    v_dot2_f32_bf16 v48, v223, v27, v48
    v_dot2_f32_bf16 v49, v223, v31, v49
    s_waitcnt vmcnt(5)
    buffer_load_dwordx4 v[140:143], v4, s[36:39], s48 offen offset:384 nt
    v_dot2_f32_bf16 v48, v224, v32, v48
    v_dot2_f32_bf16 v49, v224, v36, v49
    v_dot2_f32_bf16 v48, v225, v33, v48
    v_dot2_f32_bf16 v49, v225, v37, v49
    v_dot2_f32_bf16 v48, v226, v34, v48
    v_dot2_f32_bf16 v49, v226, v38, v49
    v_dot2_f32_bf16 v48, v227, v35, v48
    v_dot2_f32_bf16 v49, v227, v39, v49
    v_dot2_f32_bf16 v48, v228, v40, v48
    v_dot2_f32_bf16 v49, v228, v44, v49
    v_dot2_f32_bf16 v48, v229, v41, v48
    v_dot2_f32_bf16 v49, v229, v45, v49
    v_dot2_f32_bf16 v48, v230, v42, v48
    v_dot2_f32_bf16 v49, v230, v46, v49
    v_dot2_f32_bf16 v48, v231, v43, v48
    v_dot2_f32_bf16 v49, v231, v47, v49
    v_dot2_f32_bf16 v50, v232, v16, 0
    v_dot2_f32_bf16 v51, v232, v20, 0
    v_dot2_f32_bf16 v50, v233, v17, v50
    v_dot2_f32_bf16 v51, v233, v21, v51
    v_dot2_f32_bf16 v50, v234, v18, v50
    v_dot2_f32_bf16 v51, v234, v22, v51
    v_dot2_f32_bf16 v50, v235, v19, v50
    v_dot2_f32_bf16 v51, v235, v23, v51
    v_add_f32_dpp v48, v48, v48 quad_perm:[1,0,3,2] row_mask:0xf bank_mask:0xf
    v_add_f32_dpp v49, v49, v49 quad_perm:[1,0,3,2] row_mask:0xf bank_mask:0xf
    s_nop 0
    v_add_f32_dpp v48, v48, v48 quad_perm:[2,3,0,1] row_mask:0xf bank_mask:0xf
    v_add_f32_dpp v49, v49, v49 quad_perm:[2,3,0,1] row_mask:0xf bank_mask:0xf
    s_nop 0
    v_add_f32_dpp v48, v48, v48 row_half_mirror row_mask:0xf bank_mask:0xf
    v_add_f32_dpp v49, v49, v49 row_half_mirror row_mask:0xf bank_mask:0xf
    s_nop 0
    v_cvt_pk_bf16_f32 v10, v48, v49
    ds_write_b32 v6, v10 offset:9216
    s_waitcnt vmcnt(5)
    s_mov_b32 s48, 229376
    buffer_load_dwordx4 v[144:147], v4, s[36:39], s48 offen offset:0 nt
    v_dot2_f32_bf16 v50, v236, v24, v50
    v_dot2_f32_bf16 v51, v236, v28, v51
    v_dot2_f32_bf16 v50, v237, v25, v50
    v_dot2_f32_bf16 v51, v237, v29, v51
    v_dot2_f32_bf16 v50, v238, v26, v50
    v_dot2_f32_bf16 v51, v238, v30, v51
    v_dot2_f32_bf16 v50, v239, v27, v50
    v_dot2_f32_bf16 v51, v239, v31, v51
    v_dot2_f32_bf16 v50, v240, v32, v50
    v_dot2_f32_bf16 v51, v240, v36, v51
    v_dot2_f32_bf16 v50, v241, v33, v50
    v_dot2_f32_bf16 v51, v241, v37, v51
    v_dot2_f32_bf16 v50, v242, v34, v50
    v_dot2_f32_bf16 v51, v242, v38, v51
    v_dot2_f32_bf16 v50, v243, v35, v50
    v_dot2_f32_bf16 v51, v243, v39, v51
    v_dot2_f32_bf16 v50, v244, v40, v50
    v_dot2_f32_bf16 v51, v244, v44, v51
    v_dot2_f32_bf16 v50, v245, v41, v50
    v_dot2_f32_bf16 v51, v245, v45, v51
    v_dot2_f32_bf16 v50, v246, v42, v50
    v_dot2_f32_bf16 v51, v246, v46, v51
    v_dot2_f32_bf16 v50, v247, v43, v50
    v_dot2_f32_bf16 v51, v247, v47, v51
    s_waitcnt vmcnt(5)
    buffer_load_dwordx4 v[148:151], v4, s[36:39], s48 offen offset:128 nt
    v_dot2_f32_bf16 v48, v248, v16, 0
    v_dot2_f32_bf16 v49, v248, v20, 0
    v_dot2_f32_bf16 v48, v249, v17, v48
    v_dot2_f32_bf16 v49, v249, v21, v49
    v_dot2_f32_bf16 v48, v250, v18, v48
    v_dot2_f32_bf16 v49, v250, v22, v49
    v_dot2_f32_bf16 v48, v251, v19, v48
    v_dot2_f32_bf16 v49, v251, v23, v49
    v_add_f32_dpp v50, v50, v50 quad_perm:[1,0,3,2] row_mask:0xf bank_mask:0xf
    v_add_f32_dpp v51, v51, v51 quad_perm:[1,0,3,2] row_mask:0xf bank_mask:0xf
    s_nop 0
    v_add_f32_dpp v50, v50, v50 quad_perm:[2,3,0,1] row_mask:0xf bank_mask:0xf
    v_add_f32_dpp v51, v51, v51 quad_perm:[2,3,0,1] row_mask:0xf bank_mask:0xf
    s_nop 0
    v_add_f32_dpp v50, v50, v50 row_half_mirror row_mask:0xf bank_mask:0xf
    v_add_f32_dpp v51, v51, v51 row_half_mirror row_mask:0xf bank_mask:0xf
    s_nop 0
    v_cvt_pk_bf16_f32 v10, v50, v51
    ds_write_b32 v6, v10 offset:9344
    v_dot2_f32_bf16 v48, v252, v24, v48
    v_dot2_f32_bf16 v49, v252, v28, v49
    v_dot2_f32_bf16 v48, v253, v25, v48
    v_dot2_f32_bf16 v49, v253, v29, v49
    v_dot2_f32_bf16 v48, v254, v26, v48
    v_dot2_f32_bf16 v49, v254, v30, v49
    v_dot2_f32_bf16 v48, v255, v27, v48
    v_dot2_f32_bf16 v49, v255, v31, v49
    v_dot2_f32_bf16 v48, v88, v32, v48
    v_dot2_f32_bf16 v49, v88, v36, v49
    v_dot2_f32_bf16 v48, v89, v33, v48
    v_dot2_f32_bf16 v49, v89, v37, v49
    v_dot2_f32_bf16 v48, v90, v34, v48
    v_dot2_f32_bf16 v49, v90, v38, v49
    v_dot2_f32_bf16 v48, v91, v35, v48
    v_dot2_f32_bf16 v49, v91, v39, v49
    s_waitcnt vmcnt(5)
    buffer_load_dwordx4 v[152:155], v4, s[36:39], s48 offen offset:256 nt
    v_dot2_f32_bf16 v48, v92, v40, v48
    v_dot2_f32_bf16 v49, v92, v44, v49
    v_dot2_f32_bf16 v48, v93, v41, v48
    v_dot2_f32_bf16 v49, v93, v45, v49
    v_dot2_f32_bf16 v48, v94, v42, v48
    v_dot2_f32_bf16 v49, v94, v46, v49
    v_dot2_f32_bf16 v48, v95, v43, v48
    v_dot2_f32_bf16 v49, v95, v47, v49
    v_dot2_f32_bf16 v50, v96, v16, 0
    v_dot2_f32_bf16 v51, v96, v20, 0
    v_dot2_f32_bf16 v50, v97, v17, v50
    v_dot2_f32_bf16 v51, v97, v21, v51
    v_dot2_f32_bf16 v50, v98, v18, v50
    v_dot2_f32_bf16 v51, v98, v22, v51
    v_dot2_f32_bf16 v50, v99, v19, v50
    v_dot2_f32_bf16 v51, v99, v23, v51
    v_add_f32_dpp v48, v48, v48 quad_perm:[1,0,3,2] row_mask:0xf bank_mask:0xf
    v_add_f32_dpp v49, v49, v49 quad_perm:[1,0,3,2] row_mask:0xf bank_mask:0xf
    s_nop 0
    v_add_f32_dpp v48, v48, v48 quad_perm:[2,3,0,1] row_mask:0xf bank_mask:0xf
    v_add_f32_dpp v49, v49, v49 quad_perm:[2,3,0,1] row_mask:0xf bank_mask:0xf
    s_nop 0
    v_add_f32_dpp v48, v48, v48 row_half_mirror row_mask:0xf bank_mask:0xf
    v_add_f32_dpp v49, v49, v49 row_half_mirror row_mask:0xf bank_mask:0xf
    s_nop 0
    v_cvt_pk_bf16_f32 v10, v48, v49
    ds_write_b32 v6, v10 offset:9472
    v_dot2_f32_bf16 v50, v100, v24, v50
    v_dot2_f32_bf16 v51, v100, v28, v51
    v_dot2_f32_bf16 v50, v101, v25, v50
    v_dot2_f32_bf16 v51, v101, v29, v51
    v_dot2_f32_bf16 v50, v102, v26, v50
    v_dot2_f32_bf16 v51, v102, v30, v51
    v_dot2_f32_bf16 v50, v103, v27, v50
    v_dot2_f32_bf16 v51, v103, v31, v51
    s_waitcnt vmcnt(5)
    buffer_load_dwordx4 v[156:159], v4, s[36:39], s48 offen offset:384 nt
    v_dot2_f32_bf16 v50, v104, v32, v50
    v_dot2_f32_bf16 v51, v104, v36, v51
    v_dot2_f32_bf16 v50, v105, v33, v50
    v_dot2_f32_bf16 v51, v105, v37, v51
    v_dot2_f32_bf16 v50, v106, v34, v50
    v_dot2_f32_bf16 v51, v106, v38, v51
    v_dot2_f32_bf16 v50, v107, v35, v50
    v_dot2_f32_bf16 v51, v107, v39, v51
    v_dot2_f32_bf16 v50, v108, v40, v50
    v_dot2_f32_bf16 v51, v108, v44, v51
    v_dot2_f32_bf16 v50, v109, v41, v50
    v_dot2_f32_bf16 v51, v109, v45, v51
    v_dot2_f32_bf16 v50, v110, v42, v50
    v_dot2_f32_bf16 v51, v110, v46, v51
    v_dot2_f32_bf16 v50, v111, v43, v50
    v_dot2_f32_bf16 v51, v111, v47, v51
    v_dot2_f32_bf16 v48, v112, v16, 0
    v_dot2_f32_bf16 v49, v112, v20, 0
    v_dot2_f32_bf16 v48, v113, v17, v48
    v_dot2_f32_bf16 v49, v113, v21, v49
    v_dot2_f32_bf16 v48, v114, v18, v48
    v_dot2_f32_bf16 v49, v114, v22, v49
    v_dot2_f32_bf16 v48, v115, v19, v48
    v_dot2_f32_bf16 v49, v115, v23, v49
    v_add_f32_dpp v50, v50, v50 quad_perm:[1,0,3,2] row_mask:0xf bank_mask:0xf
    v_add_f32_dpp v51, v51, v51 quad_perm:[1,0,3,2] row_mask:0xf bank_mask:0xf
    s_nop 0
    v_add_f32_dpp v50, v50, v50 quad_perm:[2,3,0,1] row_mask:0xf bank_mask:0xf
    v_add_f32_dpp v51, v51, v51 quad_perm:[2,3,0,1] row_mask:0xf bank_mask:0xf
    s_nop 0
    v_add_f32_dpp v50, v50, v50 row_half_mirror row_mask:0xf bank_mask:0xf
    v_add_f32_dpp v51, v51, v51 row_half_mirror row_mask:0xf bank_mask:0xf
    s_nop 0
    v_cvt_pk_bf16_f32 v10, v50, v51
    ds_write_b32 v6, v10 offset:9600
    s_waitcnt vmcnt(5)
    s_mov_b32 s48, 245760
    buffer_load_dwordx4 v[160:163], v4, s[36:39], s48 offen offset:0 nt
    v_dot2_f32_bf16 v48, v116, v24, v48
    v_dot2_f32_bf16 v49, v116, v28, v49
    v_dot2_f32_bf16 v48, v117, v25, v48
    v_dot2_f32_bf16 v49, v117, v29, v49
    v_dot2_f32_bf16 v48, v118, v26, v48
    v_dot2_f32_bf16 v49, v118, v30, v49
    v_dot2_f32_bf16 v48, v119, v27, v48
    v_dot2_f32_bf16 v49, v119, v31, v49
    v_dot2_f32_bf16 v48, v120, v32, v48
    v_dot2_f32_bf16 v49, v120, v36, v49
    v_dot2_f32_bf16 v48, v121, v33, v48
    v_dot2_f32_bf16 v49, v121, v37, v49
    v_dot2_f32_bf16 v48, v122, v34, v48
    v_dot2_f32_bf16 v49, v122, v38, v49
    v_dot2_f32_bf16 v48, v123, v35, v48
    v_dot2_f32_bf16 v49, v123, v39, v49
    v_dot2_f32_bf16 v48, v124, v40, v48
    v_dot2_f32_bf16 v49, v124, v44, v49
    v_dot2_f32_bf16 v48, v125, v41, v48
    v_dot2_f32_bf16 v49, v125, v45, v49
    v_dot2_f32_bf16 v48, v126, v42, v48
    v_dot2_f32_bf16 v49, v126, v46, v49
    v_dot2_f32_bf16 v48, v127, v43, v48
    v_dot2_f32_bf16 v49, v127, v47, v49
    s_waitcnt vmcnt(5)
    buffer_load_dwordx4 v[164:167], v4, s[36:39], s48 offen offset:128 nt
    v_dot2_f32_bf16 v50, v128, v16, 0
    v_dot2_f32_bf16 v51, v128, v20, 0
    v_dot2_f32_bf16 v50, v129, v17, v50
    v_dot2_f32_bf16 v51, v129, v21, v51
    v_dot2_f32_bf16 v50, v130, v18, v50
    v_dot2_f32_bf16 v51, v130, v22, v51
    v_dot2_f32_bf16 v50, v131, v19, v50
    v_dot2_f32_bf16 v51, v131, v23, v51
    v_add_f32_dpp v48, v48, v48 quad_perm:[1,0,3,2] row_mask:0xf bank_mask:0xf
    v_add_f32_dpp v49, v49, v49 quad_perm:[1,0,3,2] row_mask:0xf bank_mask:0xf
    s_nop 0
    v_add_f32_dpp v48, v48, v48 quad_perm:[2,3,0,1] row_mask:0xf bank_mask:0xf
    v_add_f32_dpp v49, v49, v49 quad_perm:[2,3,0,1] row_mask:0xf bank_mask:0xf
    s_nop 0
    v_add_f32_dpp v48, v48, v48 row_half_mirror row_mask:0xf bank_mask:0xf
    v_add_f32_dpp v49, v49, v49 row_half_mirror row_mask:0xf bank_mask:0xf
    s_nop 0
    v_cvt_pk_bf16_f32 v10, v48, v49
    ds_write_b32 v6, v10 offset:9728
    v_dot2_f32_bf16 v50, v132, v24, v50
    v_dot2_f32_bf16 v51, v132, v28, v51
    v_dot2_f32_bf16 v50, v133, v25, v50
    v_dot2_f32_bf16 v51, v133, v29, v51
    v_dot2_f32_bf16 v50, v134, v26, v50
    v_dot2_f32_bf16 v51, v134, v30, v51
    v_dot2_f32_bf16 v50, v135, v27, v50
    v_dot2_f32_bf16 v51, v135, v31, v51
    v_dot2_f32_bf16 v50, v136, v32, v50
    v_dot2_f32_bf16 v51, v136, v36, v51
    v_dot2_f32_bf16 v50, v137, v33, v50
    v_dot2_f32_bf16 v51, v137, v37, v51
    v_dot2_f32_bf16 v50, v138, v34, v50
    v_dot2_f32_bf16 v51, v138, v38, v51
    v_dot2_f32_bf16 v50, v139, v35, v50
    v_dot2_f32_bf16 v51, v139, v39, v51
    s_waitcnt vmcnt(5)
    buffer_load_dwordx4 v[168:171], v4, s[36:39], s48 offen offset:256 nt
    v_dot2_f32_bf16 v50, v140, v40, v50
    v_dot2_f32_bf16 v51, v140, v44, v51
    v_dot2_f32_bf16 v50, v141, v41, v50
    v_dot2_f32_bf16 v51, v141, v45, v51
    v_dot2_f32_bf16 v50, v142, v42, v50
    v_dot2_f32_bf16 v51, v142, v46, v51
    v_dot2_f32_bf16 v50, v143, v43, v50
    v_dot2_f32_bf16 v51, v143, v47, v51
    v_dot2_f32_bf16 v48, v144, v16, 0
    v_dot2_f32_bf16 v49, v144, v20, 0
    v_dot2_f32_bf16 v48, v145, v17, v48
    v_dot2_f32_bf16 v49, v145, v21, v49
    v_dot2_f32_bf16 v48, v146, v18, v48
    v_dot2_f32_bf16 v49, v146, v22, v49
    v_dot2_f32_bf16 v48, v147, v19, v48
    v_dot2_f32_bf16 v49, v147, v23, v49
    v_add_f32_dpp v50, v50, v50 quad_perm:[1,0,3,2] row_mask:0xf bank_mask:0xf
    v_add_f32_dpp v51, v51, v51 quad_perm:[1,0,3,2] row_mask:0xf bank_mask:0xf
    s_nop 0
    v_add_f32_dpp v50, v50, v50 quad_perm:[2,3,0,1] row_mask:0xf bank_mask:0xf
    v_add_f32_dpp v51, v51, v51 quad_perm:[2,3,0,1] row_mask:0xf bank_mask:0xf
    s_nop 0
    v_add_f32_dpp v50, v50, v50 row_half_mirror row_mask:0xf bank_mask:0xf
    v_add_f32_dpp v51, v51, v51 row_half_mirror row_mask:0xf bank_mask:0xf
    s_nop 0
    v_cvt_pk_bf16_f32 v10, v50, v51
    ds_write_b32 v6, v10 offset:9856
    s_waitcnt vmcnt(5)
    buffer_load_dwordx4 v[172:175], v4, s[36:39], s48 offen offset:384 nt
    v_dot2_f32_bf16 v48, v148, v24, v48
    v_dot2_f32_bf16 v49, v148, v28, v49
    v_dot2_f32_bf16 v48, v149, v25, v48
    v_dot2_f32_bf16 v49, v149, v29, v49
    v_dot2_f32_bf16 v48, v150, v26, v48
    v_dot2_f32_bf16 v49, v150, v30, v49
    v_dot2_f32_bf16 v48, v151, v27, v48
    v_dot2_f32_bf16 v49, v151, v31, v49
    s_waitcnt vmcnt(5)
    s_mov_b32 s48, 262144
    buffer_load_dwordx4 v[176:179], v4, s[36:39], s48 offen offset:0 nt
    v_dot2_f32_bf16 v48, v152, v32, v48
    v_dot2_f32_bf16 v49, v152, v36, v49
    v_dot2_f32_bf16 v48, v153, v33, v48
    v_dot2_f32_bf16 v49, v153, v37, v49
    v_dot2_f32_bf16 v48, v154, v34, v48
    v_dot2_f32_bf16 v49, v154, v38, v49
    v_dot2_f32_bf16 v48, v155, v35, v48
    v_dot2_f32_bf16 v49, v155, v39, v49
    s_waitcnt vmcnt(5)
    buffer_load_dwordx4 v[180:183], v4, s[36:39], s48 offen offset:128 nt
    v_dot2_f32_bf16 v48, v156, v40, v48
    v_dot2_f32_bf16 v49, v156, v44, v49
    v_dot2_f32_bf16 v48, v157, v41, v48
    v_dot2_f32_bf16 v49, v157, v45, v49
    v_dot2_f32_bf16 v48, v158, v42, v48
    v_dot2_f32_bf16 v49, v158, v46, v49
    v_dot2_f32_bf16 v48, v159, v43, v48
    v_dot2_f32_bf16 v49, v159, v47, v49
    s_waitcnt vmcnt(5)
    buffer_load_dwordx4 v[184:187], v4, s[36:39], s48 offen offset:256 nt
    v_dot2_f32_bf16 v50, v160, v16, 0
    v_dot2_f32_bf16 v51, v160, v20, 0
    v_dot2_f32_bf16 v50, v161, v17, v50
    v_dot2_f32_bf16 v51, v161, v21, v51
    v_dot2_f32_bf16 v50, v162, v18, v50
    v_dot2_f32_bf16 v51, v162, v22, v51
    v_dot2_f32_bf16 v50, v163, v19, v50
    v_dot2_f32_bf16 v51, v163, v23, v51
    v_add_f32_dpp v48, v48, v48 quad_perm:[1,0,3,2] row_mask:0xf bank_mask:0xf
    v_add_f32_dpp v49, v49, v49 quad_perm:[1,0,3,2] row_mask:0xf bank_mask:0xf
    s_nop 0
    v_add_f32_dpp v48, v48, v48 quad_perm:[2,3,0,1] row_mask:0xf bank_mask:0xf
    v_add_f32_dpp v49, v49, v49 quad_perm:[2,3,0,1] row_mask:0xf bank_mask:0xf
    s_nop 0
    v_add_f32_dpp v48, v48, v48 row_half_mirror row_mask:0xf bank_mask:0xf
    v_add_f32_dpp v49, v49, v49 row_half_mirror row_mask:0xf bank_mask:0xf
    s_nop 0
    v_cvt_pk_bf16_f32 v10, v48, v49
    ds_write_b32 v6, v10 offset:9984
    s_waitcnt vmcnt(5)
    buffer_load_dwordx4 v[188:191], v4, s[36:39], s48 offen offset:384 nt
    v_dot2_f32_bf16 v50, v164, v24, v50
    v_dot2_f32_bf16 v51, v164, v28, v51
    v_dot2_f32_bf16 v50, v165, v25, v50
    v_dot2_f32_bf16 v51, v165, v29, v51
    v_dot2_f32_bf16 v50, v166, v26, v50
    v_dot2_f32_bf16 v51, v166, v30, v51
    v_dot2_f32_bf16 v50, v167, v27, v50
    v_dot2_f32_bf16 v51, v167, v31, v51
    s_waitcnt vmcnt(5)
    s_mov_b32 s48, 278528
    buffer_load_dwordx4 v[192:195], v4, s[36:39], s48 offen offset:0 nt
    v_dot2_f32_bf16 v50, v168, v32, v50
    v_dot2_f32_bf16 v51, v168, v36, v51
    v_dot2_f32_bf16 v50, v169, v33, v50
    v_dot2_f32_bf16 v51, v169, v37, v51
    v_dot2_f32_bf16 v50, v170, v34, v50
    v_dot2_f32_bf16 v51, v170, v38, v51
    v_dot2_f32_bf16 v50, v171, v35, v50
    v_dot2_f32_bf16 v51, v171, v39, v51
    s_waitcnt vmcnt(5)
    buffer_load_dwordx4 v[196:199], v4, s[36:39], s48 offen offset:128 nt
    v_dot2_f32_bf16 v50, v172, v40, v50
    v_dot2_f32_bf16 v51, v172, v44, v51
    v_dot2_f32_bf16 v50, v173, v41, v50
    v_dot2_f32_bf16 v51, v173, v45, v51
    v_dot2_f32_bf16 v50, v174, v42, v50
    v_dot2_f32_bf16 v51, v174, v46, v51
    v_dot2_f32_bf16 v50, v175, v43, v50
    v_dot2_f32_bf16 v51, v175, v47, v51
    s_waitcnt vmcnt(5)
    buffer_load_dwordx4 v[200:203], v4, s[36:39], s48 offen offset:256 nt
    v_dot2_f32_bf16 v48, v176, v16, 0
    v_dot2_f32_bf16 v49, v176, v20, 0
    v_dot2_f32_bf16 v48, v177, v17, v48
    v_dot2_f32_bf16 v49, v177, v21, v49
    v_dot2_f32_bf16 v48, v178, v18, v48
    v_dot2_f32_bf16 v49, v178, v22, v49
    v_dot2_f32_bf16 v48, v179, v19, v48
    v_dot2_f32_bf16 v49, v179, v23, v49
    v_add_f32_dpp v50, v50, v50 quad_perm:[1,0,3,2] row_mask:0xf bank_mask:0xf
    v_add_f32_dpp v51, v51, v51 quad_perm:[1,0,3,2] row_mask:0xf bank_mask:0xf
    s_nop 0
    v_add_f32_dpp v50, v50, v50 quad_perm:[2,3,0,1] row_mask:0xf bank_mask:0xf
    v_add_f32_dpp v51, v51, v51 quad_perm:[2,3,0,1] row_mask:0xf bank_mask:0xf
    s_nop 0
    v_add_f32_dpp v50, v50, v50 row_half_mirror row_mask:0xf bank_mask:0xf
    v_add_f32_dpp v51, v51, v51 row_half_mirror row_mask:0xf bank_mask:0xf
    s_nop 0
    v_cvt_pk_bf16_f32 v10, v50, v51
    ds_write_b32 v6, v10 offset:10112
    s_waitcnt vmcnt(5)
    buffer_load_dwordx4 v[204:207], v4, s[36:39], s48 offen offset:384 nt
    v_dot2_f32_bf16 v48, v180, v24, v48
    v_dot2_f32_bf16 v49, v180, v28, v49
    v_dot2_f32_bf16 v48, v181, v25, v48
    v_dot2_f32_bf16 v49, v181, v29, v49
    v_dot2_f32_bf16 v48, v182, v26, v48
    v_dot2_f32_bf16 v49, v182, v30, v49
    v_dot2_f32_bf16 v48, v183, v27, v48
    v_dot2_f32_bf16 v49, v183, v31, v49
    s_waitcnt vmcnt(5)
    s_mov_b32 s48, 294912
    buffer_load_dwordx4 v[208:211], v4, s[36:39], s48 offen offset:0 nt
    v_dot2_f32_bf16 v48, v184, v32, v48
    v_dot2_f32_bf16 v49, v184, v36, v49
    v_dot2_f32_bf16 v48, v185, v33, v48
    v_dot2_f32_bf16 v49, v185, v37, v49
    v_dot2_f32_bf16 v48, v186, v34, v48
    v_dot2_f32_bf16 v49, v186, v38, v49
    v_dot2_f32_bf16 v48, v187, v35, v48
    v_dot2_f32_bf16 v49, v187, v39, v49
    s_waitcnt vmcnt(5)
    buffer_load_dwordx4 v[212:215], v4, s[36:39], s48 offen offset:128 nt
    v_dot2_f32_bf16 v48, v188, v40, v48
    v_dot2_f32_bf16 v49, v188, v44, v49
    v_dot2_f32_bf16 v48, v189, v41, v48
    v_dot2_f32_bf16 v49, v189, v45, v49
    v_dot2_f32_bf16 v48, v190, v42, v48
    v_dot2_f32_bf16 v49, v190, v46, v49
    v_dot2_f32_bf16 v48, v191, v43, v48
    v_dot2_f32_bf16 v49, v191, v47, v49
    s_waitcnt vmcnt(5)
    buffer_load_dwordx4 v[216:219], v4, s[36:39], s48 offen offset:256 nt
    v_dot2_f32_bf16 v50, v192, v16, 0
    v_dot2_f32_bf16 v51, v192, v20, 0
    v_dot2_f32_bf16 v50, v193, v17, v50
    v_dot2_f32_bf16 v51, v193, v21, v51
    v_dot2_f32_bf16 v50, v194, v18, v50
    v_dot2_f32_bf16 v51, v194, v22, v51
    v_dot2_f32_bf16 v50, v195, v19, v50
    v_dot2_f32_bf16 v51, v195, v23, v51
    v_add_f32_dpp v48, v48, v48 quad_perm:[1,0,3,2] row_mask:0xf bank_mask:0xf
    v_add_f32_dpp v49, v49, v49 quad_perm:[1,0,3,2] row_mask:0xf bank_mask:0xf
    s_nop 0
    v_add_f32_dpp v48, v48, v48 quad_perm:[2,3,0,1] row_mask:0xf bank_mask:0xf
    v_add_f32_dpp v49, v49, v49 quad_perm:[2,3,0,1] row_mask:0xf bank_mask:0xf
    s_nop 0
    v_add_f32_dpp v48, v48, v48 row_half_mirror row_mask:0xf bank_mask:0xf
    v_add_f32_dpp v49, v49, v49 row_half_mirror row_mask:0xf bank_mask:0xf
    s_nop 0
    v_cvt_pk_bf16_f32 v10, v48, v49
    ds_write_b32 v6, v10 offset:10240
    s_waitcnt vmcnt(5)
    buffer_load_dwordx4 v[220:223], v4, s[36:39], s48 offen offset:384 nt
    v_dot2_f32_bf16 v50, v196, v24, v50
    v_dot2_f32_bf16 v51, v196, v28, v51
    v_dot2_f32_bf16 v50, v197, v25, v50
    v_dot2_f32_bf16 v51, v197, v29, v51
    v_dot2_f32_bf16 v50, v198, v26, v50
    v_dot2_f32_bf16 v51, v198, v30, v51
    v_dot2_f32_bf16 v50, v199, v27, v50
    v_dot2_f32_bf16 v51, v199, v31, v51
    s_waitcnt vmcnt(5)
    s_mov_b32 s48, 311296
    buffer_load_dwordx4 v[224:227], v4, s[36:39], s48 offen offset:0 nt
    v_dot2_f32_bf16 v50, v200, v32, v50
    v_dot2_f32_bf16 v51, v200, v36, v51
    v_dot2_f32_bf16 v50, v201, v33, v50
    v_dot2_f32_bf16 v51, v201, v37, v51
    v_dot2_f32_bf16 v50, v202, v34, v50
    v_dot2_f32_bf16 v51, v202, v38, v51
    v_dot2_f32_bf16 v50, v203, v35, v50
    v_dot2_f32_bf16 v51, v203, v39, v51
    s_waitcnt vmcnt(5)
    buffer_load_dwordx4 v[228:231], v4, s[36:39], s48 offen offset:128 nt
    v_dot2_f32_bf16 v50, v204, v40, v50
    v_dot2_f32_bf16 v51, v204, v44, v51
    v_dot2_f32_bf16 v50, v205, v41, v50
    v_dot2_f32_bf16 v51, v205, v45, v51
    v_dot2_f32_bf16 v50, v206, v42, v50
    v_dot2_f32_bf16 v51, v206, v46, v51
    v_dot2_f32_bf16 v50, v207, v43, v50
    v_dot2_f32_bf16 v51, v207, v47, v51
    s_waitcnt vmcnt(5)
    buffer_load_dwordx4 v[232:235], v4, s[36:39], s48 offen offset:256 nt
    v_dot2_f32_bf16 v48, v208, v16, 0
    v_dot2_f32_bf16 v49, v208, v20, 0
    v_dot2_f32_bf16 v48, v209, v17, v48
    v_dot2_f32_bf16 v49, v209, v21, v49
    v_dot2_f32_bf16 v48, v210, v18, v48
    v_dot2_f32_bf16 v49, v210, v22, v49
    v_dot2_f32_bf16 v48, v211, v19, v48
    v_dot2_f32_bf16 v49, v211, v23, v49
    v_add_f32_dpp v50, v50, v50 quad_perm:[1,0,3,2] row_mask:0xf bank_mask:0xf
    v_add_f32_dpp v51, v51, v51 quad_perm:[1,0,3,2] row_mask:0xf bank_mask:0xf
    s_nop 0
    v_add_f32_dpp v50, v50, v50 quad_perm:[2,3,0,1] row_mask:0xf bank_mask:0xf
    v_add_f32_dpp v51, v51, v51 quad_perm:[2,3,0,1] row_mask:0xf bank_mask:0xf
    s_nop 0
    v_add_f32_dpp v50, v50, v50 row_half_mirror row_mask:0xf bank_mask:0xf
    v_add_f32_dpp v51, v51, v51 row_half_mirror row_mask:0xf bank_mask:0xf
    s_nop 0
    v_cvt_pk_bf16_f32 v10, v50, v51
    ds_write_b32 v6, v10 offset:10368
    s_waitcnt vmcnt(5)
    buffer_load_dwordx4 v[236:239], v4, s[36:39], s48 offen offset:384 nt
    v_dot2_f32_bf16 v48, v212, v24, v48
    v_dot2_f32_bf16 v49, v212, v28, v49
    v_dot2_f32_bf16 v48, v213, v25, v48
    v_dot2_f32_bf16 v49, v213, v29, v49
    v_dot2_f32_bf16 v48, v214, v26, v48
    v_dot2_f32_bf16 v49, v214, v30, v49
    v_dot2_f32_bf16 v48, v215, v27, v48
    v_dot2_f32_bf16 v49, v215, v31, v49
    s_waitcnt vmcnt(5)
    s_mov_b32 s48, 327680
    buffer_load_dwordx4 v[240:243], v4, s[36:39], s48 offen offset:0 nt
    v_dot2_f32_bf16 v48, v216, v32, v48
    v_dot2_f32_bf16 v49, v216, v36, v49
    v_dot2_f32_bf16 v48, v217, v33, v48
    v_dot2_f32_bf16 v49, v217, v37, v49
    v_dot2_f32_bf16 v48, v218, v34, v48
    v_dot2_f32_bf16 v49, v218, v38, v49
    v_dot2_f32_bf16 v48, v219, v35, v48
    v_dot2_f32_bf16 v49, v219, v39, v49
    s_waitcnt vmcnt(5)
    buffer_load_dwordx4 v[244:247], v4, s[36:39], s48 offen offset:128 nt
    v_dot2_f32_bf16 v48, v220, v40, v48
    v_dot2_f32_bf16 v49, v220, v44, v49
    v_dot2_f32_bf16 v48, v221, v41, v48
    v_dot2_f32_bf16 v49, v221, v45, v49
    v_dot2_f32_bf16 v48, v222, v42, v48
    v_dot2_f32_bf16 v49, v222, v46, v49
    v_dot2_f32_bf16 v48, v223, v43, v48
    v_dot2_f32_bf16 v49, v223, v47, v49
    s_waitcnt vmcnt(5)
    buffer_load_dwordx4 v[248:251], v4, s[36:39], s48 offen offset:256 nt
    v_dot2_f32_bf16 v50, v224, v16, 0
    v_dot2_f32_bf16 v51, v224, v20, 0
    v_dot2_f32_bf16 v50, v225, v17, v50
    v_dot2_f32_bf16 v51, v225, v21, v51
    v_dot2_f32_bf16 v50, v226, v18, v50
    v_dot2_f32_bf16 v51, v226, v22, v51
    v_dot2_f32_bf16 v50, v227, v19, v50
    v_dot2_f32_bf16 v51, v227, v23, v51
    v_add_f32_dpp v48, v48, v48 quad_perm:[1,0,3,2] row_mask:0xf bank_mask:0xf
    v_add_f32_dpp v49, v49, v49 quad_perm:[1,0,3,2] row_mask:0xf bank_mask:0xf
    s_nop 0
    v_add_f32_dpp v48, v48, v48 quad_perm:[2,3,0,1] row_mask:0xf bank_mask:0xf
    v_add_f32_dpp v49, v49, v49 quad_perm:[2,3,0,1] row_mask:0xf bank_mask:0xf
    s_nop 0
    v_add_f32_dpp v48, v48, v48 row_half_mirror row_mask:0xf bank_mask:0xf
    v_add_f32_dpp v49, v49, v49 row_half_mirror row_mask:0xf bank_mask:0xf
    s_nop 0
    v_cvt_pk_bf16_f32 v10, v48, v49
    ds_write_b32 v6, v10 offset:10496
    s_waitcnt vmcnt(5)
    buffer_load_dwordx4 v[252:255], v4, s[36:39], s48 offen offset:384 nt
    v_dot2_f32_bf16 v50, v228, v24, v50
    v_dot2_f32_bf16 v51, v228, v28, v51
    v_dot2_f32_bf16 v50, v229, v25, v50
    v_dot2_f32_bf16 v51, v229, v29, v51
    v_dot2_f32_bf16 v50, v230, v26, v50
    v_dot2_f32_bf16 v51, v230, v30, v51
    v_dot2_f32_bf16 v50, v231, v27, v50
    v_dot2_f32_bf16 v51, v231, v31, v51
    s_waitcnt vmcnt(5)
    s_mov_b32 s48, 344064
    buffer_load_dwordx4 v[88:91], v4, s[36:39], s48 offen offset:0 nt
    v_dot2_f32_bf16 v50, v232, v32, v50
    v_dot2_f32_bf16 v51, v232, v36, v51
    v_dot2_f32_bf16 v50, v233, v33, v50
    v_dot2_f32_bf16 v51, v233, v37, v51
    v_dot2_f32_bf16 v50, v234, v34, v50
    v_dot2_f32_bf16 v51, v234, v38, v51
    v_dot2_f32_bf16 v50, v235, v35, v50
    v_dot2_f32_bf16 v51, v235, v39, v51
    s_waitcnt vmcnt(5)
    buffer_load_dwordx4 v[92:95], v4, s[36:39], s48 offen offset:128 nt
    v_dot2_f32_bf16 v50, v236, v40, v50
    v_dot2_f32_bf16 v51, v236, v44, v51
    v_dot2_f32_bf16 v50, v237, v41, v50
    v_dot2_f32_bf16 v51, v237, v45, v51
    v_dot2_f32_bf16 v50, v238, v42, v50
    v_dot2_f32_bf16 v51, v238, v46, v51
    v_dot2_f32_bf16 v50, v239, v43, v50
    v_dot2_f32_bf16 v51, v239, v47, v51
    s_waitcnt vmcnt(5)
    buffer_load_dwordx4 v[96:99], v4, s[36:39], s48 offen offset:256 nt
    v_dot2_f32_bf16 v48, v240, v16, 0
    v_dot2_f32_bf16 v49, v240, v20, 0
    v_dot2_f32_bf16 v48, v241, v17, v48
    v_dot2_f32_bf16 v49, v241, v21, v49
    v_dot2_f32_bf16 v48, v242, v18, v48
    v_dot2_f32_bf16 v49, v242, v22, v49
    v_dot2_f32_bf16 v48, v243, v19, v48
    v_dot2_f32_bf16 v49, v243, v23, v49
    v_add_f32_dpp v50, v50, v50 quad_perm:[1,0,3,2] row_mask:0xf bank_mask:0xf
    v_add_f32_dpp v51, v51, v51 quad_perm:[1,0,3,2] row_mask:0xf bank_mask:0xf
    s_nop 0
    v_add_f32_dpp v50, v50, v50 quad_perm:[2,3,0,1] row_mask:0xf bank_mask:0xf
    v_add_f32_dpp v51, v51, v51 quad_perm:[2,3,0,1] row_mask:0xf bank_mask:0xf
    s_nop 0
    v_add_f32_dpp v50, v50, v50 row_half_mirror row_mask:0xf bank_mask:0xf
    v_add_f32_dpp v51, v51, v51 row_half_mirror row_mask:0xf bank_mask:0xf
    s_nop 0
    v_cvt_pk_bf16_f32 v10, v50, v51
    ds_write_b32 v6, v10 offset:10624
    s_waitcnt vmcnt(5)
    buffer_load_dwordx4 v[100:103], v4, s[36:39], s48 offen offset:384 nt
    v_dot2_f32_bf16 v48, v244, v24, v48
    v_dot2_f32_bf16 v49, v244, v28, v49
    v_dot2_f32_bf16 v48, v245, v25, v48
    v_dot2_f32_bf16 v49, v245, v29, v49
    v_dot2_f32_bf16 v48, v246, v26, v48
    v_dot2_f32_bf16 v49, v246, v30, v49
    v_dot2_f32_bf16 v48, v247, v27, v48
    v_dot2_f32_bf16 v49, v247, v31, v49
    s_waitcnt vmcnt(5)
    s_mov_b32 s48, 360448
    buffer_load_dwordx4 v[104:107], v4, s[36:39], s48 offen offset:0 nt
    v_dot2_f32_bf16 v48, v248, v32, v48
    v_dot2_f32_bf16 v49, v248, v36, v49
    v_dot2_f32_bf16 v48, v249, v33, v48
    v_dot2_f32_bf16 v49, v249, v37, v49
    v_dot2_f32_bf16 v48, v250, v34, v48
    v_dot2_f32_bf16 v49, v250, v38, v49
    v_dot2_f32_bf16 v48, v251, v35, v48
    v_dot2_f32_bf16 v49, v251, v39, v49
    s_waitcnt vmcnt(5)
    buffer_load_dwordx4 v[108:111], v4, s[36:39], s48 offen offset:128 nt
    v_dot2_f32_bf16 v48, v252, v40, v48
    v_dot2_f32_bf16 v49, v252, v44, v49
    v_dot2_f32_bf16 v48, v253, v41, v48
    v_dot2_f32_bf16 v49, v253, v45, v49
    v_dot2_f32_bf16 v48, v254, v42, v48
    v_dot2_f32_bf16 v49, v254, v46, v49
    v_dot2_f32_bf16 v48, v255, v43, v48
    v_dot2_f32_bf16 v49, v255, v47, v49
    s_waitcnt vmcnt(5)
    buffer_load_dwordx4 v[112:115], v4, s[36:39], s48 offen offset:256 nt
    v_dot2_f32_bf16 v50, v88, v16, 0
    v_dot2_f32_bf16 v51, v88, v20, 0
    v_dot2_f32_bf16 v50, v89, v17, v50
    v_dot2_f32_bf16 v51, v89, v21, v51
    v_dot2_f32_bf16 v50, v90, v18, v50
    v_dot2_f32_bf16 v51, v90, v22, v51
    v_dot2_f32_bf16 v50, v91, v19, v50
    v_dot2_f32_bf16 v51, v91, v23, v51
    v_add_f32_dpp v48, v48, v48 quad_perm:[1,0,3,2] row_mask:0xf bank_mask:0xf
    v_add_f32_dpp v49, v49, v49 quad_perm:[1,0,3,2] row_mask:0xf bank_mask:0xf
    s_nop 0
    v_add_f32_dpp v48, v48, v48 quad_perm:[2,3,0,1] row_mask:0xf bank_mask:0xf
    v_add_f32_dpp v49, v49, v49 quad_perm:[2,3,0,1] row_mask:0xf bank_mask:0xf
    s_nop 0
    v_add_f32_dpp v48, v48, v48 row_half_mirror row_mask:0xf bank_mask:0xf
    v_add_f32_dpp v49, v49, v49 row_half_mirror row_mask:0xf bank_mask:0xf
    s_nop 0
    v_cvt_pk_bf16_f32 v10, v48, v49
    ds_write_b32 v6, v10 offset:10752
    s_waitcnt vmcnt(5)
    buffer_load_dwordx4 v[116:119], v4, s[36:39], s48 offen offset:384 nt
    v_dot2_f32_bf16 v50, v92, v24, v50
    v_dot2_f32_bf16 v51, v92, v28, v51
    v_dot2_f32_bf16 v50, v93, v25, v50
    v_dot2_f32_bf16 v51, v93, v29, v51
    v_dot2_f32_bf16 v50, v94, v26, v50
    v_dot2_f32_bf16 v51, v94, v30, v51
    v_dot2_f32_bf16 v50, v95, v27, v50
    v_dot2_f32_bf16 v51, v95, v31, v51
    s_waitcnt vmcnt(5)
    s_mov_b32 s48, 376832
    buffer_load_dwordx4 v[120:123], v4, s[36:39], s48 offen offset:0 nt
    v_dot2_f32_bf16 v50, v96, v32, v50
    v_dot2_f32_bf16 v51, v96, v36, v51
    v_dot2_f32_bf16 v50, v97, v33, v50
    v_dot2_f32_bf16 v51, v97, v37, v51
    v_dot2_f32_bf16 v50, v98, v34, v50
    v_dot2_f32_bf16 v51, v98, v38, v51
    v_dot2_f32_bf16 v50, v99, v35, v50
    v_dot2_f32_bf16 v51, v99, v39, v51
    s_waitcnt vmcnt(5)
    buffer_load_dwordx4 v[124:127], v4, s[36:39], s48 offen offset:128 nt
    v_dot2_f32_bf16 v50, v100, v40, v50
    v_dot2_f32_bf16 v51, v100, v44, v51
    v_dot2_f32_bf16 v50, v101, v41, v50
    v_dot2_f32_bf16 v51, v101, v45, v51
    v_dot2_f32_bf16 v50, v102, v42, v50
    v_dot2_f32_bf16 v51, v102, v46, v51
    v_dot2_f32_bf16 v50, v103, v43, v50
    v_dot2_f32_bf16 v51, v103, v47, v51
    s_waitcnt vmcnt(5)
    buffer_load_dwordx4 v[128:131], v4, s[36:39], s48 offen offset:256 nt
    v_dot2_f32_bf16 v48, v104, v16, 0
    v_dot2_f32_bf16 v49, v104, v20, 0
    v_dot2_f32_bf16 v48, v105, v17, v48
    v_dot2_f32_bf16 v49, v105, v21, v49
    v_dot2_f32_bf16 v48, v106, v18, v48
    v_dot2_f32_bf16 v49, v106, v22, v49
    v_dot2_f32_bf16 v48, v107, v19, v48
    v_dot2_f32_bf16 v49, v107, v23, v49
    v_add_f32_dpp v50, v50, v50 quad_perm:[1,0,3,2] row_mask:0xf bank_mask:0xf
    v_add_f32_dpp v51, v51, v51 quad_perm:[1,0,3,2] row_mask:0xf bank_mask:0xf
    s_nop 0
    v_add_f32_dpp v50, v50, v50 quad_perm:[2,3,0,1] row_mask:0xf bank_mask:0xf
    v_add_f32_dpp v51, v51, v51 quad_perm:[2,3,0,1] row_mask:0xf bank_mask:0xf
    s_nop 0
    v_add_f32_dpp v50, v50, v50 row_half_mirror row_mask:0xf bank_mask:0xf
    v_add_f32_dpp v51, v51, v51 row_half_mirror row_mask:0xf bank_mask:0xf
    s_nop 0
    v_cvt_pk_bf16_f32 v10, v50, v51
    ds_write_b32 v6, v10 offset:10880
    s_waitcnt vmcnt(5)
    buffer_load_dwordx4 v[132:135], v4, s[36:39], s48 offen offset:384 nt
    v_dot2_f32_bf16 v48, v108, v24, v48
    v_dot2_f32_bf16 v49, v108, v28, v49
    v_dot2_f32_bf16 v48, v109, v25, v48
    v_dot2_f32_bf16 v49, v109, v29, v49
    v_dot2_f32_bf16 v48, v110, v26, v48
    v_dot2_f32_bf16 v49, v110, v30, v49
    v_dot2_f32_bf16 v48, v111, v27, v48
    v_dot2_f32_bf16 v49, v111, v31, v49
    s_waitcnt vmcnt(5)
    s_mov_b32 s48, 393216
    buffer_load_dwordx4 v[136:139], v4, s[36:39], s48 offen offset:0 nt
    v_dot2_f32_bf16 v48, v112, v32, v48
    v_dot2_f32_bf16 v49, v112, v36, v49
    v_dot2_f32_bf16 v48, v113, v33, v48
    v_dot2_f32_bf16 v49, v113, v37, v49
    v_dot2_f32_bf16 v48, v114, v34, v48
    v_dot2_f32_bf16 v49, v114, v38, v49
    v_dot2_f32_bf16 v48, v115, v35, v48
    v_dot2_f32_bf16 v49, v115, v39, v49
    s_waitcnt vmcnt(5)
    buffer_load_dwordx4 v[140:143], v4, s[36:39], s48 offen offset:128 nt
    v_dot2_f32_bf16 v48, v116, v40, v48
    v_dot2_f32_bf16 v49, v116, v44, v49
    v_dot2_f32_bf16 v48, v117, v41, v48
    v_dot2_f32_bf16 v49, v117, v45, v49
    v_dot2_f32_bf16 v48, v118, v42, v48
    v_dot2_f32_bf16 v49, v118, v46, v49
    v_dot2_f32_bf16 v48, v119, v43, v48
    v_dot2_f32_bf16 v49, v119, v47, v49
    s_waitcnt vmcnt(5)
    buffer_load_dwordx4 v[144:147], v4, s[36:39], s48 offen offset:256 nt
    v_dot2_f32_bf16 v50, v120, v16, 0
    v_dot2_f32_bf16 v51, v120, v20, 0
    v_dot2_f32_bf16 v50, v121, v17, v50
    v_dot2_f32_bf16 v51, v121, v21, v51
    v_dot2_f32_bf16 v50, v122, v18, v50
    v_dot2_f32_bf16 v51, v122, v22, v51
    v_dot2_f32_bf16 v50, v123, v19, v50
    v_dot2_f32_bf16 v51, v123, v23, v51
    v_add_f32_dpp v48, v48, v48 quad_perm:[1,0,3,2] row_mask:0xf bank_mask:0xf
    v_add_f32_dpp v49, v49, v49 quad_perm:[1,0,3,2] row_mask:0xf bank_mask:0xf
    s_nop 0
    v_add_f32_dpp v48, v48, v48 quad_perm:[2,3,0,1] row_mask:0xf bank_mask:0xf
    v_add_f32_dpp v49, v49, v49 quad_perm:[2,3,0,1] row_mask:0xf bank_mask:0xf
    s_nop 0
    v_add_f32_dpp v48, v48, v48 row_half_mirror row_mask:0xf bank_mask:0xf
    v_add_f32_dpp v49, v49, v49 row_half_mirror row_mask:0xf bank_mask:0xf
    s_nop 0
    v_cvt_pk_bf16_f32 v10, v48, v49
    ds_write_b32 v6, v10 offset:11008
    s_waitcnt vmcnt(5)
    buffer_load_dwordx4 v[148:151], v4, s[36:39], s48 offen offset:384 nt
    v_dot2_f32_bf16 v50, v124, v24, v50
    v_dot2_f32_bf16 v51, v124, v28, v51
    v_dot2_f32_bf16 v50, v125, v25, v50
    v_dot2_f32_bf16 v51, v125, v29, v51
    v_dot2_f32_bf16 v50, v126, v26, v50
    v_dot2_f32_bf16 v51, v126, v30, v51
    v_dot2_f32_bf16 v50, v127, v27, v50
    v_dot2_f32_bf16 v51, v127, v31, v51
    s_waitcnt vmcnt(5)
    s_mov_b32 s48, 409600
    buffer_load_dwordx4 v[152:155], v4, s[36:39], s48 offen offset:0 nt
    v_dot2_f32_bf16 v50, v128, v32, v50
    v_dot2_f32_bf16 v51, v128, v36, v51
    v_dot2_f32_bf16 v50, v129, v33, v50
    v_dot2_f32_bf16 v51, v129, v37, v51
    v_dot2_f32_bf16 v50, v130, v34, v50
    v_dot2_f32_bf16 v51, v130, v38, v51
    v_dot2_f32_bf16 v50, v131, v35, v50
    v_dot2_f32_bf16 v51, v131, v39, v51
    s_waitcnt vmcnt(5)
    buffer_load_dwordx4 v[156:159], v4, s[36:39], s48 offen offset:128 nt
    v_dot2_f32_bf16 v50, v132, v40, v50
    v_dot2_f32_bf16 v51, v132, v44, v51
    v_dot2_f32_bf16 v50, v133, v41, v50
    v_dot2_f32_bf16 v51, v133, v45, v51
    v_dot2_f32_bf16 v50, v134, v42, v50
    v_dot2_f32_bf16 v51, v134, v46, v51
    v_dot2_f32_bf16 v50, v135, v43, v50
    v_dot2_f32_bf16 v51, v135, v47, v51
    s_waitcnt vmcnt(5)
    buffer_load_dwordx4 v[160:163], v4, s[36:39], s48 offen offset:256 nt
    v_dot2_f32_bf16 v48, v136, v16, 0
    v_dot2_f32_bf16 v49, v136, v20, 0
    v_dot2_f32_bf16 v48, v137, v17, v48
    v_dot2_f32_bf16 v49, v137, v21, v49
    v_dot2_f32_bf16 v48, v138, v18, v48
    v_dot2_f32_bf16 v49, v138, v22, v49
    v_dot2_f32_bf16 v48, v139, v19, v48
    v_dot2_f32_bf16 v49, v139, v23, v49
    v_add_f32_dpp v50, v50, v50 quad_perm:[1,0,3,2] row_mask:0xf bank_mask:0xf
    v_add_f32_dpp v51, v51, v51 quad_perm:[1,0,3,2] row_mask:0xf bank_mask:0xf
    s_nop 0
    v_add_f32_dpp v50, v50, v50 quad_perm:[2,3,0,1] row_mask:0xf bank_mask:0xf
    v_add_f32_dpp v51, v51, v51 quad_perm:[2,3,0,1] row_mask:0xf bank_mask:0xf
    s_nop 0
    v_add_f32_dpp v50, v50, v50 row_half_mirror row_mask:0xf bank_mask:0xf
    v_add_f32_dpp v51, v51, v51 row_half_mirror row_mask:0xf bank_mask:0xf
    s_nop 0
    v_cvt_pk_bf16_f32 v10, v50, v51
    ds_write_b32 v6, v10 offset:11136
    s_waitcnt vmcnt(5)
    buffer_load_dwordx4 v[164:167], v4, s[36:39], s48 offen offset:384 nt
    v_dot2_f32_bf16 v48, v140, v24, v48
    v_dot2_f32_bf16 v49, v140, v28, v49
    v_dot2_f32_bf16 v48, v141, v25, v48
    v_dot2_f32_bf16 v49, v141, v29, v49
    v_dot2_f32_bf16 v48, v142, v26, v48
    v_dot2_f32_bf16 v49, v142, v30, v49
    v_dot2_f32_bf16 v48, v143, v27, v48
    v_dot2_f32_bf16 v49, v143, v31, v49
    s_waitcnt vmcnt(5)
    s_mov_b32 s48, 425984
    buffer_load_dwordx4 v[168:171], v4, s[36:39], s48 offen offset:0 nt
    v_dot2_f32_bf16 v48, v144, v32, v48
    v_dot2_f32_bf16 v49, v144, v36, v49
    v_dot2_f32_bf16 v48, v145, v33, v48
    v_dot2_f32_bf16 v49, v145, v37, v49
    v_dot2_f32_bf16 v48, v146, v34, v48
    v_dot2_f32_bf16 v49, v146, v38, v49
    v_dot2_f32_bf16 v48, v147, v35, v48
    v_dot2_f32_bf16 v49, v147, v39, v49
    s_waitcnt vmcnt(5)
    buffer_load_dwordx4 v[172:175], v4, s[36:39], s48 offen offset:128 nt
    v_dot2_f32_bf16 v48, v148, v40, v48
    v_dot2_f32_bf16 v49, v148, v44, v49
    v_dot2_f32_bf16 v48, v149, v41, v48
    v_dot2_f32_bf16 v49, v149, v45, v49
    v_dot2_f32_bf16 v48, v150, v42, v48
    v_dot2_f32_bf16 v49, v150, v46, v49
    v_dot2_f32_bf16 v48, v151, v43, v48
    v_dot2_f32_bf16 v49, v151, v47, v49
    s_waitcnt vmcnt(5)
    buffer_load_dwordx4 v[176:179], v4, s[36:39], s48 offen offset:256 nt
    v_dot2_f32_bf16 v50, v152, v16, 0
    v_dot2_f32_bf16 v51, v152, v20, 0
    v_dot2_f32_bf16 v50, v153, v17, v50
    v_dot2_f32_bf16 v51, v153, v21, v51
    v_dot2_f32_bf16 v50, v154, v18, v50
    v_dot2_f32_bf16 v51, v154, v22, v51
    v_dot2_f32_bf16 v50, v155, v19, v50
    v_dot2_f32_bf16 v51, v155, v23, v51
    v_add_f32_dpp v48, v48, v48 quad_perm:[1,0,3,2] row_mask:0xf bank_mask:0xf
    v_add_f32_dpp v49, v49, v49 quad_perm:[1,0,3,2] row_mask:0xf bank_mask:0xf
    s_nop 0
    v_add_f32_dpp v48, v48, v48 quad_perm:[2,3,0,1] row_mask:0xf bank_mask:0xf
    v_add_f32_dpp v49, v49, v49 quad_perm:[2,3,0,1] row_mask:0xf bank_mask:0xf
    s_nop 0
    v_add_f32_dpp v48, v48, v48 row_half_mirror row_mask:0xf bank_mask:0xf
    v_add_f32_dpp v49, v49, v49 row_half_mirror row_mask:0xf bank_mask:0xf
    s_nop 0
    v_cvt_pk_bf16_f32 v10, v48, v49
    ds_write_b32 v6, v10 offset:11264
    s_waitcnt vmcnt(5)
    buffer_load_dwordx4 v[180:183], v4, s[36:39], s48 offen offset:384 nt
    v_dot2_f32_bf16 v50, v156, v24, v50
    v_dot2_f32_bf16 v51, v156, v28, v51
    v_dot2_f32_bf16 v50, v157, v25, v50
    v_dot2_f32_bf16 v51, v157, v29, v51
    v_dot2_f32_bf16 v50, v158, v26, v50
    v_dot2_f32_bf16 v51, v158, v30, v51
    v_dot2_f32_bf16 v50, v159, v27, v50
    v_dot2_f32_bf16 v51, v159, v31, v51
    s_waitcnt vmcnt(5)
    s_mov_b32 s48, 442368
    buffer_load_dwordx4 v[184:187], v4, s[36:39], s48 offen offset:0 nt
    v_dot2_f32_bf16 v50, v160, v32, v50
    v_dot2_f32_bf16 v51, v160, v36, v51
    v_dot2_f32_bf16 v50, v161, v33, v50
    v_dot2_f32_bf16 v51, v161, v37, v51
    v_dot2_f32_bf16 v50, v162, v34, v50
    v_dot2_f32_bf16 v51, v162, v38, v51
    v_dot2_f32_bf16 v50, v163, v35, v50
    v_dot2_f32_bf16 v51, v163, v39, v51
    s_waitcnt vmcnt(5)
    buffer_load_dwordx4 v[188:191], v4, s[36:39], s48 offen offset:128 nt
    v_dot2_f32_bf16 v50, v164, v40, v50
    v_dot2_f32_bf16 v51, v164, v44, v51
    v_dot2_f32_bf16 v50, v165, v41, v50
    v_dot2_f32_bf16 v51, v165, v45, v51
    v_dot2_f32_bf16 v50, v166, v42, v50
    v_dot2_f32_bf16 v51, v166, v46, v51
    v_dot2_f32_bf16 v50, v167, v43, v50
    v_dot2_f32_bf16 v51, v167, v47, v51
    s_waitcnt vmcnt(5)
    buffer_load_dwordx4 v[192:195], v4, s[36:39], s48 offen offset:256 nt
    v_dot2_f32_bf16 v48, v168, v16, 0
    v_dot2_f32_bf16 v49, v168, v20, 0
    v_dot2_f32_bf16 v48, v169, v17, v48
    v_dot2_f32_bf16 v49, v169, v21, v49
    v_dot2_f32_bf16 v48, v170, v18, v48
    v_dot2_f32_bf16 v49, v170, v22, v49
    v_dot2_f32_bf16 v48, v171, v19, v48
    v_dot2_f32_bf16 v49, v171, v23, v49
    v_add_f32_dpp v50, v50, v50 quad_perm:[1,0,3,2] row_mask:0xf bank_mask:0xf
    v_add_f32_dpp v51, v51, v51 quad_perm:[1,0,3,2] row_mask:0xf bank_mask:0xf
    s_nop 0
    v_add_f32_dpp v50, v50, v50 quad_perm:[2,3,0,1] row_mask:0xf bank_mask:0xf
    v_add_f32_dpp v51, v51, v51 quad_perm:[2,3,0,1] row_mask:0xf bank_mask:0xf
    s_nop 0
    v_add_f32_dpp v50, v50, v50 row_half_mirror row_mask:0xf bank_mask:0xf
    v_add_f32_dpp v51, v51, v51 row_half_mirror row_mask:0xf bank_mask:0xf
    s_nop 0
    v_cvt_pk_bf16_f32 v10, v50, v51
    ds_write_b32 v6, v10 offset:11392
    s_waitcnt vmcnt(5)
    buffer_load_dwordx4 v[196:199], v4, s[36:39], s48 offen offset:384 nt
    v_dot2_f32_bf16 v48, v172, v24, v48
    v_dot2_f32_bf16 v49, v172, v28, v49
    v_dot2_f32_bf16 v48, v173, v25, v48
    v_dot2_f32_bf16 v49, v173, v29, v49
    v_dot2_f32_bf16 v48, v174, v26, v48
    v_dot2_f32_bf16 v49, v174, v30, v49
    v_dot2_f32_bf16 v48, v175, v27, v48
    v_dot2_f32_bf16 v49, v175, v31, v49
    s_waitcnt vmcnt(5)
    s_mov_b32 s48, 458752
    buffer_load_dwordx4 v[200:203], v4, s[36:39], s48 offen offset:0 nt
    v_dot2_f32_bf16 v48, v176, v32, v48
    v_dot2_f32_bf16 v49, v176, v36, v49
    v_dot2_f32_bf16 v48, v177, v33, v48
    v_dot2_f32_bf16 v49, v177, v37, v49
    v_dot2_f32_bf16 v48, v178, v34, v48
    v_dot2_f32_bf16 v49, v178, v38, v49
    v_dot2_f32_bf16 v48, v179, v35, v48
    v_dot2_f32_bf16 v49, v179, v39, v49
    s_waitcnt vmcnt(5)
    buffer_load_dwordx4 v[204:207], v4, s[36:39], s48 offen offset:128 nt
    v_dot2_f32_bf16 v48, v180, v40, v48
    v_dot2_f32_bf16 v49, v180, v44, v49
    v_dot2_f32_bf16 v48, v181, v41, v48
    v_dot2_f32_bf16 v49, v181, v45, v49
    v_dot2_f32_bf16 v48, v182, v42, v48
    v_dot2_f32_bf16 v49, v182, v46, v49
    v_dot2_f32_bf16 v48, v183, v43, v48
    v_dot2_f32_bf16 v49, v183, v47, v49
    s_waitcnt vmcnt(5)
    buffer_load_dwordx4 v[208:211], v4, s[36:39], s48 offen offset:256 nt
    v_dot2_f32_bf16 v50, v184, v16, 0
    v_dot2_f32_bf16 v51, v184, v20, 0
    v_dot2_f32_bf16 v50, v185, v17, v50
    v_dot2_f32_bf16 v51, v185, v21, v51
    v_dot2_f32_bf16 v50, v186, v18, v50
    v_dot2_f32_bf16 v51, v186, v22, v51
    v_dot2_f32_bf16 v50, v187, v19, v50
    v_dot2_f32_bf16 v51, v187, v23, v51
    v_add_f32_dpp v48, v48, v48 quad_perm:[1,0,3,2] row_mask:0xf bank_mask:0xf
    v_add_f32_dpp v49, v49, v49 quad_perm:[1,0,3,2] row_mask:0xf bank_mask:0xf
    s_nop 0
    v_add_f32_dpp v48, v48, v48 quad_perm:[2,3,0,1] row_mask:0xf bank_mask:0xf
    v_add_f32_dpp v49, v49, v49 quad_perm:[2,3,0,1] row_mask:0xf bank_mask:0xf
    s_nop 0
    v_add_f32_dpp v48, v48, v48 row_half_mirror row_mask:0xf bank_mask:0xf
    v_add_f32_dpp v49, v49, v49 row_half_mirror row_mask:0xf bank_mask:0xf
    s_nop 0
    v_cvt_pk_bf16_f32 v10, v48, v49
    ds_write_b32 v6, v10 offset:11520
    s_waitcnt vmcnt(5)
    buffer_load_dwordx4 v[212:215], v4, s[36:39], s48 offen offset:384 nt
    v_dot2_f32_bf16 v50, v188, v24, v50
    v_dot2_f32_bf16 v51, v188, v28, v51
    v_dot2_f32_bf16 v50, v189, v25, v50
    v_dot2_f32_bf16 v51, v189, v29, v51
    v_dot2_f32_bf16 v50, v190, v26, v50
    v_dot2_f32_bf16 v51, v190, v30, v51
    v_dot2_f32_bf16 v50, v191, v27, v50
    v_dot2_f32_bf16 v51, v191, v31, v51
    s_waitcnt vmcnt(5)
    s_mov_b32 s48, 475136
    buffer_load_dwordx4 v[216:219], v4, s[36:39], s48 offen offset:0 nt
    v_dot2_f32_bf16 v50, v192, v32, v50
    v_dot2_f32_bf16 v51, v192, v36, v51
    v_dot2_f32_bf16 v50, v193, v33, v50
    v_dot2_f32_bf16 v51, v193, v37, v51
    v_dot2_f32_bf16 v50, v194, v34, v50
    v_dot2_f32_bf16 v51, v194, v38, v51
    v_dot2_f32_bf16 v50, v195, v35, v50
    v_dot2_f32_bf16 v51, v195, v39, v51
    s_waitcnt vmcnt(5)
    buffer_load_dwordx4 v[220:223], v4, s[36:39], s48 offen offset:128 nt
    v_dot2_f32_bf16 v50, v196, v40, v50
    v_dot2_f32_bf16 v51, v196, v44, v51
    v_dot2_f32_bf16 v50, v197, v41, v50
    v_dot2_f32_bf16 v51, v197, v45, v51
    v_dot2_f32_bf16 v50, v198, v42, v50
    v_dot2_f32_bf16 v51, v198, v46, v51
    v_dot2_f32_bf16 v50, v199, v43, v50
    v_dot2_f32_bf16 v51, v199, v47, v51
    s_waitcnt vmcnt(5)
    buffer_load_dwordx4 v[224:227], v4, s[36:39], s48 offen offset:256 nt
    v_dot2_f32_bf16 v48, v200, v16, 0
    v_dot2_f32_bf16 v49, v200, v20, 0
    v_dot2_f32_bf16 v48, v201, v17, v48
    v_dot2_f32_bf16 v49, v201, v21, v49
    v_dot2_f32_bf16 v48, v202, v18, v48
    v_dot2_f32_bf16 v49, v202, v22, v49
    v_dot2_f32_bf16 v48, v203, v19, v48
    v_dot2_f32_bf16 v49, v203, v23, v49
    v_add_f32_dpp v50, v50, v50 quad_perm:[1,0,3,2] row_mask:0xf bank_mask:0xf
    v_add_f32_dpp v51, v51, v51 quad_perm:[1,0,3,2] row_mask:0xf bank_mask:0xf
    s_nop 0
    v_add_f32_dpp v50, v50, v50 quad_perm:[2,3,0,1] row_mask:0xf bank_mask:0xf
    v_add_f32_dpp v51, v51, v51 quad_perm:[2,3,0,1] row_mask:0xf bank_mask:0xf
    s_nop 0
    v_add_f32_dpp v50, v50, v50 row_half_mirror row_mask:0xf bank_mask:0xf
    v_add_f32_dpp v51, v51, v51 row_half_mirror row_mask:0xf bank_mask:0xf
    s_nop 0
    v_cvt_pk_bf16_f32 v10, v50, v51
    ds_write_b32 v6, v10 offset:11648
    s_waitcnt vmcnt(5)
    buffer_load_dwordx4 v[228:231], v4, s[36:39], s48 offen offset:384 nt
    v_dot2_f32_bf16 v48, v204, v24, v48
    v_dot2_f32_bf16 v49, v204, v28, v49
    v_dot2_f32_bf16 v48, v205, v25, v48
    v_dot2_f32_bf16 v49, v205, v29, v49
    v_dot2_f32_bf16 v48, v206, v26, v48
    v_dot2_f32_bf16 v49, v206, v30, v49
    v_dot2_f32_bf16 v48, v207, v27, v48
    v_dot2_f32_bf16 v49, v207, v31, v49
    s_waitcnt vmcnt(5)
    s_mov_b32 s48, 491520
    buffer_load_dwordx4 v[232:235], v4, s[36:39], s48 offen offset:0 nt
    v_dot2_f32_bf16 v48, v208, v32, v48
    v_dot2_f32_bf16 v49, v208, v36, v49
    v_dot2_f32_bf16 v48, v209, v33, v48
    v_dot2_f32_bf16 v49, v209, v37, v49
    v_dot2_f32_bf16 v48, v210, v34, v48
    v_dot2_f32_bf16 v49, v210, v38, v49
    v_dot2_f32_bf16 v48, v211, v35, v48
    v_dot2_f32_bf16 v49, v211, v39, v49
    s_waitcnt vmcnt(5)
    buffer_load_dwordx4 v[236:239], v4, s[36:39], s48 offen offset:128 nt
    v_dot2_f32_bf16 v48, v212, v40, v48
    v_dot2_f32_bf16 v49, v212, v44, v49
    v_dot2_f32_bf16 v48, v213, v41, v48
    v_dot2_f32_bf16 v49, v213, v45, v49
    v_dot2_f32_bf16 v48, v214, v42, v48
    v_dot2_f32_bf16 v49, v214, v46, v49
    v_dot2_f32_bf16 v48, v215, v43, v48
    v_dot2_f32_bf16 v49, v215, v47, v49
    s_waitcnt vmcnt(5)
    buffer_load_dwordx4 v[240:243], v4, s[36:39], s48 offen offset:256 nt
    v_dot2_f32_bf16 v50, v216, v16, 0
    v_dot2_f32_bf16 v51, v216, v20, 0
    v_dot2_f32_bf16 v50, v217, v17, v50
    v_dot2_f32_bf16 v51, v217, v21, v51
    v_dot2_f32_bf16 v50, v218, v18, v50
    v_dot2_f32_bf16 v51, v218, v22, v51
    v_dot2_f32_bf16 v50, v219, v19, v50
    v_dot2_f32_bf16 v51, v219, v23, v51
    v_add_f32_dpp v48, v48, v48 quad_perm:[1,0,3,2] row_mask:0xf bank_mask:0xf
    v_add_f32_dpp v49, v49, v49 quad_perm:[1,0,3,2] row_mask:0xf bank_mask:0xf
    s_nop 0
    v_add_f32_dpp v48, v48, v48 quad_perm:[2,3,0,1] row_mask:0xf bank_mask:0xf
    v_add_f32_dpp v49, v49, v49 quad_perm:[2,3,0,1] row_mask:0xf bank_mask:0xf
    s_nop 0
    v_add_f32_dpp v48, v48, v48 row_half_mirror row_mask:0xf bank_mask:0xf
    v_add_f32_dpp v49, v49, v49 row_half_mirror row_mask:0xf bank_mask:0xf
    s_nop 0
    v_cvt_pk_bf16_f32 v10, v48, v49
    ds_write_b32 v6, v10 offset:11776
    s_waitcnt vmcnt(5)
    buffer_load_dwordx4 v[244:247], v4, s[36:39], s48 offen offset:384 nt
    v_dot2_f32_bf16 v50, v220, v24, v50
    v_dot2_f32_bf16 v51, v220, v28, v51
    v_dot2_f32_bf16 v50, v221, v25, v50
    v_dot2_f32_bf16 v51, v221, v29, v51
    v_dot2_f32_bf16 v50, v222, v26, v50
    v_dot2_f32_bf16 v51, v222, v30, v51
    v_dot2_f32_bf16 v50, v223, v27, v50
    v_dot2_f32_bf16 v51, v223, v31, v51
    s_waitcnt vmcnt(5)
    s_mov_b32 s48, 507904
    buffer_load_dwordx4 v[248:251], v4, s[36:39], s48 offen offset:0 nt
    v_dot2_f32_bf16 v50, v224, v32, v50
    v_dot2_f32_bf16 v51, v224, v36, v51
    v_dot2_f32_bf16 v50, v225, v33, v50
    v_dot2_f32_bf16 v51, v225, v37, v51
    v_dot2_f32_bf16 v50, v226, v34, v50
    v_dot2_f32_bf16 v51, v226, v38, v51
    v_dot2_f32_bf16 v50, v227, v35, v50
    v_dot2_f32_bf16 v51, v227, v39, v51
    s_waitcnt vmcnt(5)
    buffer_load_dwordx4 v[252:255], v4, s[36:39], s48 offen offset:128 nt
    v_dot2_f32_bf16 v50, v228, v40, v50
    v_dot2_f32_bf16 v51, v228, v44, v51
    v_dot2_f32_bf16 v50, v229, v41, v50
    v_dot2_f32_bf16 v51, v229, v45, v51
    v_dot2_f32_bf16 v50, v230, v42, v50
    v_dot2_f32_bf16 v51, v230, v46, v51
    v_dot2_f32_bf16 v50, v231, v43, v50
    v_dot2_f32_bf16 v51, v231, v47, v51
    s_waitcnt vmcnt(5)
    buffer_load_dwordx4 v[88:91], v4, s[36:39], s48 offen offset:256 nt
    v_dot2_f32_bf16 v48, v232, v16, 0
    v_dot2_f32_bf16 v49, v232, v20, 0
    v_dot2_f32_bf16 v48, v233, v17, v48
    v_dot2_f32_bf16 v49, v233, v21, v49
    v_dot2_f32_bf16 v48, v234, v18, v48
    v_dot2_f32_bf16 v49, v234, v22, v49
    v_dot2_f32_bf16 v48, v235, v19, v48
    v_dot2_f32_bf16 v49, v235, v23, v49
    v_add_f32_dpp v50, v50, v50 quad_perm:[1,0,3,2] row_mask:0xf bank_mask:0xf
    v_add_f32_dpp v51, v51, v51 quad_perm:[1,0,3,2] row_mask:0xf bank_mask:0xf
    s_nop 0
    v_add_f32_dpp v50, v50, v50 quad_perm:[2,3,0,1] row_mask:0xf bank_mask:0xf
    v_add_f32_dpp v51, v51, v51 quad_perm:[2,3,0,1] row_mask:0xf bank_mask:0xf
    s_nop 0
    v_add_f32_dpp v50, v50, v50 row_half_mirror row_mask:0xf bank_mask:0xf
    v_add_f32_dpp v51, v51, v51 row_half_mirror row_mask:0xf bank_mask:0xf
    s_nop 0
    v_cvt_pk_bf16_f32 v10, v50, v51
    ds_write_b32 v6, v10 offset:11904
    s_waitcnt vmcnt(5)
    buffer_load_dwordx4 v[92:95], v4, s[36:39], s48 offen offset:384 nt
    v_dot2_f32_bf16 v48, v236, v24, v48
    v_dot2_f32_bf16 v49, v236, v28, v49
    v_dot2_f32_bf16 v48, v237, v25, v48
    v_dot2_f32_bf16 v49, v237, v29, v49
    v_dot2_f32_bf16 v48, v238, v26, v48
    v_dot2_f32_bf16 v49, v238, v30, v49
    v_dot2_f32_bf16 v48, v239, v27, v48
    v_dot2_f32_bf16 v49, v239, v31, v49
    s_waitcnt vmcnt(5)
    s_mov_b32 s48, 0
    buffer_load_dwordx4 v[96:99], v5, s[40:43], s48 offen offset:0 nt
    v_dot2_f32_bf16 v48, v240, v32, v48
    v_dot2_f32_bf16 v49, v240, v36, v49
    v_dot2_f32_bf16 v48, v241, v33, v48
    v_dot2_f32_bf16 v49, v241, v37, v49
    v_dot2_f32_bf16 v48, v242, v34, v48
    v_dot2_f32_bf16 v49, v242, v38, v49
    v_dot2_f32_bf16 v48, v243, v35, v48
    v_dot2_f32_bf16 v49, v243, v39, v49
    s_waitcnt vmcnt(5)
    buffer_load_dwordx4 v[100:103], v5, s[40:43], s48 offen offset:1024 nt
    v_dot2_f32_bf16 v48, v244, v40, v48
    v_dot2_f32_bf16 v49, v244, v44, v49
    v_dot2_f32_bf16 v48, v245, v41, v48
    v_dot2_f32_bf16 v49, v245, v45, v49
    v_dot2_f32_bf16 v48, v246, v42, v48
    v_dot2_f32_bf16 v49, v246, v46, v49
    v_dot2_f32_bf16 v48, v247, v43, v48
    v_dot2_f32_bf16 v49, v247, v47, v49
    s_waitcnt vmcnt(5)
    buffer_load_dwordx4 v[104:107], v5, s[40:43], s48 offen offset:2048 nt
    v_dot2_f32_bf16 v50, v248, v16, 0
    v_dot2_f32_bf16 v51, v248, v20, 0
    v_dot2_f32_bf16 v50, v249, v17, v50
    v_dot2_f32_bf16 v51, v249, v21, v51
    v_dot2_f32_bf16 v50, v250, v18, v50
    v_dot2_f32_bf16 v51, v250, v22, v51
    v_dot2_f32_bf16 v50, v251, v19, v50
    v_dot2_f32_bf16 v51, v251, v23, v51
    v_add_f32_dpp v48, v48, v48 quad_perm:[1,0,3,2] row_mask:0xf bank_mask:0xf
    v_add_f32_dpp v49, v49, v49 quad_perm:[1,0,3,2] row_mask:0xf bank_mask:0xf
    s_nop 0
    v_add_f32_dpp v48, v48, v48 quad_perm:[2,3,0,1] row_mask:0xf bank_mask:0xf
    v_add_f32_dpp v49, v49, v49 quad_perm:[2,3,0,1] row_mask:0xf bank_mask:0xf
    s_nop 0
    v_add_f32_dpp v48, v48, v48 row_half_mirror row_mask:0xf bank_mask:0xf
    v_add_f32_dpp v49, v49, v49 row_half_mirror row_mask:0xf bank_mask:0xf
    s_nop 0
    v_cvt_pk_bf16_f32 v10, v48, v49
    ds_write_b32 v6, v10 offset:12032
    s_waitcnt vmcnt(5)
    buffer_load_dwordx4 v[108:111], v5, s[40:43], s48 offen offset:3072 nt
    v_dot2_f32_bf16 v50, v252, v24, v50
    v_dot2_f32_bf16 v51, v252, v28, v51
    v_dot2_f32_bf16 v50, v253, v25, v50
    v_dot2_f32_bf16 v51, v253, v29, v51
    v_dot2_f32_bf16 v50, v254, v26, v50
    v_dot2_f32_bf16 v51, v254, v30, v51
    v_dot2_f32_bf16 v50, v255, v27, v50
    v_dot2_f32_bf16 v51, v255, v31, v51
    s_waitcnt vmcnt(5)
    s_mov_b32 s48, 4096
    buffer_load_dwordx4 v[112:115], v5, s[40:43], s48 offen offset:0 nt
    v_dot2_f32_bf16 v50, v88, v32, v50
    v_dot2_f32_bf16 v51, v88, v36, v51
    v_dot2_f32_bf16 v50, v89, v33, v50
    v_dot2_f32_bf16 v51, v89, v37, v51
    v_dot2_f32_bf16 v50, v90, v34, v50
    v_dot2_f32_bf16 v51, v90, v38, v51
    v_dot2_f32_bf16 v50, v91, v35, v50
    v_dot2_f32_bf16 v51, v91, v39, v51
    s_waitcnt vmcnt(5)
    buffer_load_dwordx4 v[116:119], v5, s[40:43], s48 offen offset:1024 nt
    v_dot2_f32_bf16 v50, v92, v40, v50
    v_dot2_f32_bf16 v51, v92, v44, v51
    v_dot2_f32_bf16 v50, v93, v41, v50
    v_dot2_f32_bf16 v51, v93, v45, v51
    v_dot2_f32_bf16 v50, v94, v42, v50
    v_dot2_f32_bf16 v51, v94, v46, v51
    v_dot2_f32_bf16 v50, v95, v43, v50
    v_dot2_f32_bf16 v51, v95, v47, v51
    s_nop 3
    v_add_f32_dpp v50, v50, v50 quad_perm:[1,0,3,2] row_mask:0xf bank_mask:0xf
    v_add_f32_dpp v51, v51, v51 quad_perm:[1,0,3,2] row_mask:0xf bank_mask:0xf
    s_nop 0
    v_add_f32_dpp v50, v50, v50 quad_perm:[2,3,0,1] row_mask:0xf bank_mask:0xf
    v_add_f32_dpp v51, v51, v51 quad_perm:[2,3,0,1] row_mask:0xf bank_mask:0xf
    s_nop 0
    v_add_f32_dpp v50, v50, v50 row_half_mirror row_mask:0xf bank_mask:0xf
    v_add_f32_dpp v51, v51, v51 row_half_mirror row_mask:0xf bank_mask:0xf
    s_nop 0
    v_cvt_pk_bf16_f32 v10, v50, v51
    ds_write_b32 v6, v10 offset:12160
    v_mov_b32 v10, 1
    s_waitcnt lgkmcnt(0)
    s_mov_b64 exec, 1
    ds_add_u32 v8, v10 offset:8
    s_mov_b64 exec, -1
    s_waitcnt vmcnt(5)
    buffer_load_dwordx4 v[120:123], v5, s[40:43], s48 offen offset:2048 nt
    s_waitcnt vmcnt(5)
    buffer_load_dwordx4 v[124:127], v5, s[40:43], s48 offen offset:3072 nt
    s_waitcnt vmcnt(5)
    s_mov_b32 s48, 32768
    buffer_load_dwordx4 v[128:131], v5, s[40:43], s48 offen offset:0 nt
    s_waitcnt vmcnt(5)
    buffer_load_dwordx4 v[132:135], v5, s[40:43], s48 offen offset:1024 nt
    s_waitcnt vmcnt(5)
    buffer_load_dwordx4 v[136:139], v5, s[40:43], s48 offen offset:2048 nt
    s_waitcnt vmcnt(5)
    buffer_load_dwordx4 v[140:143], v5, s[40:43], s48 offen offset:3072 nt
    s_waitcnt vmcnt(5)
    s_mov_b32 s48, 36864
    buffer_load_dwordx4 v[144:147], v5, s[40:43], s48 offen offset:0 nt
    s_waitcnt vmcnt(5)
    buffer_load_dwordx4 v[148:151], v5, s[40:43], s48 offen offset:1024 nt
    s_waitcnt vmcnt(5)
    buffer_load_dwordx4 v[152:155], v5, s[40:43], s48 offen offset:2048 nt
    s_waitcnt vmcnt(5)
    buffer_load_dwordx4 v[156:159], v5, s[40:43], s48 offen offset:3072 nt
    s_waitcnt vmcnt(5)
    s_mov_b32 s48, 65536
    buffer_load_dwordx4 v[160:163], v5, s[40:43], s48 offen offset:0 nt
    s_waitcnt vmcnt(5)
    buffer_load_dwordx4 v[164:167], v5, s[40:43], s48 offen offset:1024 nt
    s_waitcnt vmcnt(5)
    buffer_load_dwordx4 v[168:171], v5, s[40:43], s48 offen offset:2048 nt
    s_waitcnt vmcnt(5)
    buffer_load_dwordx4 v[172:175], v5, s[40:43], s48 offen offset:3072 nt
    s_waitcnt vmcnt(5)
    s_mov_b32 s48, 69632
    buffer_load_dwordx4 v[176:179], v5, s[40:43], s48 offen offset:0 nt
    s_waitcnt vmcnt(5)
    buffer_load_dwordx4 v[180:183], v5, s[40:43], s48 offen offset:1024 nt
    s_waitcnt vmcnt(5)
    buffer_load_dwordx4 v[184:187], v5, s[40:43], s48 offen offset:2048 nt
    s_waitcnt vmcnt(5)
    buffer_load_dwordx4 v[188:191], v5, s[40:43], s48 offen offset:3072 nt
    s_waitcnt vmcnt(5)
    s_mov_b32 s48, 98304
    buffer_load_dwordx4 v[192:195], v5, s[40:43], s48 offen offset:0 nt
    s_waitcnt vmcnt(5)
    buffer_load_dwordx4 v[196:199], v5, s[40:43], s48 offen offset:1024 nt
    s_waitcnt vmcnt(5)
    buffer_load_dwordx4 v[200:203], v5, s[40:43], s48 offen offset:2048 nt
    s_waitcnt vmcnt(5)
    buffer_load_dwordx4 v[204:207], v5, s[40:43], s48 offen offset:3072 nt
    s_waitcnt vmcnt(5)
    s_mov_b32 s48, 102400
    buffer_load_dwordx4 v[208:211], v5, s[40:43], s48 offen offset:0 nt
    v_mov_b32 v10, 1
    ds_write_b32 v8, v10 offset:20
    s_waitcnt vmcnt(5)
    buffer_load_dwordx4 v[212:215], v5, s[40:43], s48 offen offset:1024 nt
    s_waitcnt vmcnt(5)
    buffer_load_dwordx4 v[216:219], v5, s[40:43], s48 offen offset:2048 nt
    s_waitcnt vmcnt(5)
    buffer_load_dwordx4 v[220:223], v5, s[40:43], s48 offen offset:3072 nt
    s_waitcnt vmcnt(5)
    s_mov_b32 s48, 131072
    buffer_load_dwordx4 v[224:227], v5, s[40:43], s48 offen offset:0 nt
    s_waitcnt vmcnt(5)
    buffer_load_dwordx4 v[228:231], v5, s[40:43], s48 offen offset:1024 nt
    s_waitcnt vmcnt(5)
    buffer_load_dwordx4 v[232:235], v5, s[40:43], s48 offen offset:2048 nt
    s_waitcnt vmcnt(5)
    buffer_load_dwordx4 v[236:239], v5, s[40:43], s48 offen offset:3072 nt
    s_waitcnt vmcnt(5)
    s_mov_b32 s48, 135168
    buffer_load_dwordx4 v[240:243], v5, s[40:43], s48 offen offset:0 nt
    s_waitcnt vmcnt(5)
    buffer_load_dwordx4 v[244:247], v5, s[40:43], s48 offen offset:1024 nt
    s_waitcnt vmcnt(5)
    buffer_load_dwordx4 v[248:251], v5, s[40:43], s48 offen offset:2048 nt
    s_waitcnt vmcnt(5)
    buffer_load_dwordx4 v[252:255], v5, s[40:43], s48 offen offset:3072 nt
    s_waitcnt vmcnt(5)
    s_mov_b32 s48, 163840
    buffer_load_dwordx4 v[88:91], v5, s[40:43], s48 offen offset:0 nt
    s_waitcnt vmcnt(5)
    buffer_load_dwordx4 v[92:95], v5, s[40:43], s48 offen offset:1024 nt
    v_mov_b32 v16, 0
    v_mov_b32 v17, 0
    v_mov_b32 v18, 0
    v_mov_b32 v19, 0
    v_mov_b32 v20, 0
    v_mov_b32 v21, 0
    v_mov_b32 v22, 0
    v_mov_b32 v23, 0
    v_mov_b32 v24, 0
    v_mov_b32 v25, 0
    v_mov_b32 v26, 0
    v_mov_b32 v27, 0
    v_mov_b32 v28, 0
    v_mov_b32 v29, 0
    v_mov_b32 v30, 0
    v_mov_b32 v31, 0
    v_mov_b32 v32, 0
    v_mov_b32 v33, 0
    v_mov_b32 v34, 0
    v_mov_b32 v35, 0
    v_mov_b32 v36, 0
    v_mov_b32 v37, 0
    v_mov_b32 v38, 0
    v_mov_b32 v39, 0
    v_mov_b32 v40, 0
    v_mov_b32 v41, 0
    v_mov_b32 v42, 0
    v_mov_b32 v43, 0
    v_mov_b32 v44, 0
    v_mov_b32 v45, 0
    v_mov_b32 v46, 0
    v_mov_b32 v47, 0
    s_mov_b32 s59, 800000
L_spin_3:
    ds_read_b32 v10, v8 offset:12
    s_waitcnt lgkmcnt(0)
    v_readfirstlane_b32 s50, v10
    s_nop 0
    s_cmp_eq_u32 s50, 1
    s_cbranch_scc1 L_spun_4
    s_sleep 1
    s_sub_u32 s59, s59, 1
    s_cmp_lg_u32 s59, 0
    s_cbranch_scc1 L_spin_3
L_spun_4:
    ds_read_b32 v10, v8 offset:32
    s_waitcnt lgkmcnt(0)
    v_readfirstlane_b32 s97, v10
    ds_read_b128 v[80:83], v7 offset:0
    v_perm_b32 v48, v100, v96, s56
    v_perm_b32 v52, v100, v96, s57
    v_perm_b32 v56, v101, v97, s56
    v_perm_b32 v60, v101, v97, s57
    v_perm_b32 v64, v102, v98, s56
    v_perm_b32 v68, v102, v98, s57
    v_perm_b32 v72, v103, v99, s56
    v_perm_b32 v76, v103, v99, s57
    s_waitcnt vmcnt(5)
    buffer_load_dwordx4 v[96:99], v5, s[40:43], s48 offen offset:2048 nt
    s_waitcnt vmcnt(5)
    buffer_load_dwordx4 v[100:103], v5, s[40:43], s48 offen offset:3072 nt
    v_perm_b32 v49, v108, v104, s56
    v_perm_b32 v53, v108, v104, s57
    v_perm_b32 v57, v109, v105, s56
    v_perm_b32 v61, v109, v105, s57
    v_perm_b32 v65, v110, v106, s56
    v_perm_b32 v69, v110, v106, s57
    v_perm_b32 v73, v111, v107, s56
    v_perm_b32 v77, v111, v107, s57
    s_waitcnt vmcnt(5)
    s_mov_b32 s48, 167936
    buffer_load_dwordx4 v[104:107], v5, s[40:43], s48 offen offset:0 nt
    s_waitcnt vmcnt(5)
    buffer_load_dwordx4 v[108:111], v5, s[40:43], s48 offen offset:1024 nt
    v_perm_b32 v50, v116, v112, s56
    v_perm_b32 v54, v116, v112, s57
    v_perm_b32 v58, v117, v113, s56
    v_perm_b32 v62, v117, v113, s57
    v_perm_b32 v66, v118, v114, s56
    v_perm_b32 v70, v118, v114, s57
    v_perm_b32 v74, v119, v115, s56
    v_perm_b32 v78, v119, v115, s57
    v_perm_b32 v51, v124, v120, s56
    v_perm_b32 v55, v124, v120, s57
    v_perm_b32 v59, v125, v121, s56
    v_perm_b32 v63, v125, v121, s57
    v_perm_b32 v67, v126, v122, s56
    v_perm_b32 v71, v126, v122, s57
    v_perm_b32 v75, v127, v123, s56
    v_perm_b32 v79, v127, v123, s57
    s_waitcnt lgkmcnt(0)
    ds_read_b128 v[84:87], v7 offset:256
    v_mfma_f32_16x16x32_bf16 v[16:19], v[80:83], v[48:51], v[16:19]
    v_mfma_f32_16x16x32_bf16 v[20:23], v[80:83], v[52:55], v[20:23]
    v_mfma_f32_16x16x32_bf16 v[24:27], v[80:83], v[56:59], v[24:27]
    v_mfma_f32_16x16x32_bf16 v[28:31], v[80:83], v[60:63], v[28:31]
    v_mfma_f32_16x16x32_bf16 v[32:35], v[80:83], v[64:67], v[32:35]
    v_mfma_f32_16x16x32_bf16 v[36:39], v[80:83], v[68:71], v[36:39]
    v_mfma_f32_16x16x32_bf16 v[40:43], v[80:83], v[72:75], v[40:43]
    v_mfma_f32_16x16x32_bf16 v[44:47], v[80:83], v[76:79], v[44:47]
    s_waitcnt vmcnt(5)
    buffer_load_dwordx4 v[112:115], v5, s[40:43], s48 offen offset:2048 nt
    v_perm_b32 v48, v132, v128, s56
    v_perm_b32 v52, v132, v128, s57
    v_perm_b32 v56, v133, v129, s56
    v_perm_b32 v60, v133, v129, s57
    v_perm_b32 v64, v134, v130, s56
    v_perm_b32 v68, v134, v130, s57
    v_perm_b32 v72, v135, v131, s56
    v_perm_b32 v76, v135, v131, s57
    v_perm_b32 v49, v140, v136, s56
    v_perm_b32 v53, v140, v136, s57
    v_perm_b32 v57, v141, v137, s56
    v_perm_b32 v61, v141, v137, s57
    v_perm_b32 v65, v142, v138, s56
    v_perm_b32 v69, v142, v138, s57
    v_perm_b32 v73, v143, v139, s56
    v_perm_b32 v77, v143, v139, s57
    s_waitcnt vmcnt(5)
    buffer_load_dwordx4 v[116:119], v5, s[40:43], s48 offen offset:3072 nt
    v_perm_b32 v50, v148, v144, s56
    v_perm_b32 v54, v148, v144, s57
    v_perm_b32 v58, v149, v145, s56
    v_perm_b32 v62, v149, v145, s57
    v_perm_b32 v66, v150, v146, s56
    v_perm_b32 v70, v150, v146, s57
    v_perm_b32 v74, v151, v147, s56
    v_perm_b32 v78, v151, v147, s57
    v_perm_b32 v51, v156, v152, s56
    v_perm_b32 v55, v156, v152, s57
    v_perm_b32 v59, v157, v153, s56
    v_perm_b32 v63, v157, v153, s57
    v_perm_b32 v67, v158, v154, s56
    v_perm_b32 v71, v158, v154, s57
    v_perm_b32 v75, v159, v155, s56
    v_perm_b32 v79, v159, v155, s57
    s_waitcnt lgkmcnt(0)
    ds_read_b128 v[80:83], v7 offset:512
    v_mfma_f32_16x16x32_bf16 v[16:19], v[84:87], v[48:51], v[16:19]
    v_mfma_f32_16x16x32_bf16 v[20:23], v[84:87], v[52:55], v[20:23]
    v_mfma_f32_16x16x32_bf16 v[24:27], v[84:87], v[56:59], v[24:27]
    v_mfma_f32_16x16x32_bf16 v[28:31], v[84:87], v[60:63], v[28:31]
    v_mfma_f32_16x16x32_bf16 v[32:35], v[84:87], v[64:67], v[32:35]
    v_mfma_f32_16x16x32_bf16 v[36:39], v[84:87], v[68:71], v[36:39]
    v_mfma_f32_16x16x32_bf16 v[40:43], v[84:87], v[72:75], v[40:43]
    v_mfma_f32_16x16x32_bf16 v[44:47], v[84:87], v[76:79], v[44:47]
    s_waitcnt vmcnt(5)
    s_mov_b32 s48, 196608
    buffer_load_dwordx4 v[120:123], v5, s[40:43], s48 offen offset:0 nt
    v_perm_b32 v48, v164, v160, s56
    v_perm_b32 v52, v164, v160, s57
    v_perm_b32 v56, v165, v161, s56
    v_perm_b32 v60, v165, v161, s57
    v_perm_b32 v64, v166, v162, s56
    v_perm_b32 v68, v166, v162, s57
    v_perm_b32 v72, v167, v163, s56
    v_perm_b32 v76, v167, v163, s57
    v_perm_b32 v49, v172, v168, s56
    v_perm_b32 v53, v172, v168, s57
    v_perm_b32 v57, v173, v169, s56
    v_perm_b32 v61, v173, v169, s57
    v_perm_b32 v65, v174, v170, s56
    v_perm_b32 v69, v174, v170, s57
    v_perm_b32 v73, v175, v171, s56
    v_perm_b32 v77, v175, v171, s57
    s_waitcnt vmcnt(5)
    buffer_load_dwordx4 v[124:127], v5, s[40:43], s48 offen offset:1024 nt
    v_perm_b32 v50, v180, v176, s56
    v_perm_b32 v54, v180, v176, s57
    v_perm_b32 v58, v181, v177, s56
    v_perm_b32 v62, v181, v177, s57
    v_perm_b32 v66, v182, v178, s56
    v_perm_b32 v70, v182, v178, s57
    v_perm_b32 v74, v183, v179, s56
    v_perm_b32 v78, v183, v179, s57
    v_perm_b32 v51, v188, v184, s56
    v_perm_b32 v55, v188, v184, s57
    v_perm_b32 v59, v189, v185, s56
    v_perm_b32 v63, v189, v185, s57
    v_perm_b32 v67, v190, v186, s56
    v_perm_b32 v71, v190, v186, s57
    v_perm_b32 v75, v191, v187, s56
    v_perm_b32 v79, v191, v187, s57
    s_waitcnt lgkmcnt(0)
    ds_read_b128 v[84:87], v7 offset:768
    v_mfma_f32_16x16x32_bf16 v[16:19], v[80:83], v[48:51], v[16:19]
    v_mfma_f32_16x16x32_bf16 v[20:23], v[80:83], v[52:55], v[20:23]
    v_mfma_f32_16x16x32_bf16 v[24:27], v[80:83], v[56:59], v[24:27]
    v_mfma_f32_16x16x32_bf16 v[28:31], v[80:83], v[60:63], v[28:31]
    v_mfma_f32_16x16x32_bf16 v[32:35], v[80:83], v[64:67], v[32:35]
    v_mfma_f32_16x16x32_bf16 v[36:39], v[80:83], v[68:71], v[36:39]
    v_mfma_f32_16x16x32_bf16 v[40:43], v[80:83], v[72:75], v[40:43]
    v_mfma_f32_16x16x32_bf16 v[44:47], v[80:83], v[76:79], v[44:47]
    s_waitcnt vmcnt(5)
    buffer_load_dwordx4 v[128:131], v5, s[40:43], s48 offen offset:2048 nt
    v_perm_b32 v48, v196, v192, s56
    v_perm_b32 v52, v196, v192, s57
    v_perm_b32 v56, v197, v193, s56
    v_perm_b32 v60, v197, v193, s57
    v_perm_b32 v64, v198, v194, s56
    v_perm_b32 v68, v198, v194, s57
    v_perm_b32 v72, v199, v195, s56
    v_perm_b32 v76, v199, v195, s57
    v_perm_b32 v49, v204, v200, s56
    v_perm_b32 v53, v204, v200, s57
    v_perm_b32 v57, v205, v201, s56
    v_perm_b32 v61, v205, v201, s57
    v_perm_b32 v65, v206, v202, s56
    v_perm_b32 v69, v206, v202, s57
    v_perm_b32 v73, v207, v203, s56
    v_perm_b32 v77, v207, v203, s57
    s_waitcnt vmcnt(5)
    buffer_load_dwordx4 v[132:135], v5, s[40:43], s48 offen offset:3072 nt
    v_perm_b32 v50, v212, v208, s56
    v_perm_b32 v54, v212, v208, s57
    v_perm_b32 v58, v213, v209, s56
    v_perm_b32 v62, v213, v209, s57
    v_perm_b32 v66, v214, v210, s56
    v_perm_b32 v70, v214, v210, s57
    v_perm_b32 v74, v215, v211, s56
    v_perm_b32 v78, v215, v211, s57
    v_perm_b32 v51, v220, v216, s56
    v_perm_b32 v55, v220, v216, s57
    v_perm_b32 v59, v221, v217, s56
    v_perm_b32 v63, v221, v217, s57
    v_perm_b32 v67, v222, v218, s56
    v_perm_b32 v71, v222, v218, s57
    v_perm_b32 v75, v223, v219, s56
    v_perm_b32 v79, v223, v219, s57
    s_waitcnt lgkmcnt(0)
    ds_read_b128 v[80:83], v7 offset:1024
    v_mfma_f32_16x16x32_bf16 v[16:19], v[84:87], v[48:51], v[16:19]
    v_mfma_f32_16x16x32_bf16 v[20:23], v[84:87], v[52:55], v[20:23]
    v_mfma_f32_16x16x32_bf16 v[24:27], v[84:87], v[56:59], v[24:27]
    v_mfma_f32_16x16x32_bf16 v[28:31], v[84:87], v[60:63], v[28:31]
    v_mfma_f32_16x16x32_bf16 v[32:35], v[84:87], v[64:67], v[32:35]
    v_mfma_f32_16x16x32_bf16 v[36:39], v[84:87], v[68:71], v[36:39]
    v_mfma_f32_16x16x32_bf16 v[40:43], v[84:87], v[72:75], v[40:43]
    v_mfma_f32_16x16x32_bf16 v[44:47], v[84:87], v[76:79], v[44:47]
    s_waitcnt vmcnt(5)
    s_mov_b32 s48, 200704
    buffer_load_dwordx4 v[136:139], v5, s[40:43], s48 offen offset:0 nt
    v_perm_b32 v48, v228, v224, s56
    v_perm_b32 v52, v228, v224, s57
    v_perm_b32 v56, v229, v225, s56
    v_perm_b32 v60, v229, v225, s57
    v_perm_b32 v64, v230, v226, s56
    v_perm_b32 v68, v230, v226, s57
    v_perm_b32 v72, v231, v227, s56
    v_perm_b32 v76, v231, v227, s57
    v_perm_b32 v49, v236, v232, s56
    v_perm_b32 v53, v236, v232, s57
    v_perm_b32 v57, v237, v233, s56
    v_perm_b32 v61, v237, v233, s57
    v_perm_b32 v65, v238, v234, s56
    v_perm_b32 v69, v238, v234, s57
    v_perm_b32 v73, v239, v235, s56
    v_perm_b32 v77, v239, v235, s57
    s_waitcnt vmcnt(5)
    buffer_load_dwordx4 v[140:143], v5, s[40:43], s48 offen offset:1024 nt
    v_perm_b32 v50, v244, v240, s56
    v_perm_b32 v54, v244, v240, s57
    v_perm_b32 v58, v245, v241, s56
    v_perm_b32 v62, v245, v241, s57
    v_perm_b32 v66, v246, v242, s56
    v_perm_b32 v70, v246, v242, s57
    v_perm_b32 v74, v247, v243, s56
    v_perm_b32 v78, v247, v243, s57
    v_perm_b32 v51, v252, v248, s56
    v_perm_b32 v55, v252, v248, s57
    v_perm_b32 v59, v253, v249, s56
    v_perm_b32 v63, v253, v249, s57
    v_perm_b32 v67, v254, v250, s56
    v_perm_b32 v71, v254, v250, s57
    v_perm_b32 v75, v255, v251, s56
    v_perm_b32 v79, v255, v251, s57
    s_waitcnt lgkmcnt(0)
    ds_read_b128 v[84:87], v7 offset:1280
    v_mfma_f32_16x16x32_bf16 v[16:19], v[80:83], v[48:51], v[16:19]
    v_mfma_f32_16x16x32_bf16 v[20:23], v[80:83], v[52:55], v[20:23]
    v_mfma_f32_16x16x32_bf16 v[24:27], v[80:83], v[56:59], v[24:27]
    v_mfma_f32_16x16x32_bf16 v[28:31], v[80:83], v[60:63], v[28:31]
    v_mfma_f32_16x16x32_bf16 v[32:35], v[80:83], v[64:67], v[32:35]
    v_mfma_f32_16x16x32_bf16 v[36:39], v[80:83], v[68:71], v[36:39]
    v_mfma_f32_16x16x32_bf16 v[40:43], v[80:83], v[72:75], v[40:43]
    v_mfma_f32_16x16x32_bf16 v[44:47], v[80:83], v[76:79], v[44:47]
    s_waitcnt vmcnt(5)
    buffer_load_dwordx4 v[144:147], v5, s[40:43], s48 offen offset:2048 nt
    v_perm_b32 v48, v92, v88, s56
    v_perm_b32 v52, v92, v88, s57
    v_perm_b32 v56, v93, v89, s56
    v_perm_b32 v60, v93, v89, s57
    v_perm_b32 v64, v94, v90, s56
    v_perm_b32 v68, v94, v90, s57
    v_perm_b32 v72, v95, v91, s56
    v_perm_b32 v76, v95, v91, s57
    v_perm_b32 v49, v100, v96, s56
    v_perm_b32 v53, v100, v96, s57
    v_perm_b32 v57, v101, v97, s56
    v_perm_b32 v61, v101, v97, s57
    v_perm_b32 v65, v102, v98, s56
    v_perm_b32 v69, v102, v98, s57
    v_perm_b32 v73, v103, v99, s56
    v_perm_b32 v77, v103, v99, s57
    s_waitcnt vmcnt(5)
    buffer_load_dwordx4 v[148:151], v5, s[40:43], s48 offen offset:3072 nt
    v_perm_b32 v50, v108, v104, s56
    v_perm_b32 v54, v108, v104, s57
    v_perm_b32 v58, v109, v105, s56
    v_perm_b32 v62, v109, v105, s57
    v_perm_b32 v66, v110, v106, s56
    v_perm_b32 v70, v110, v106, s57
    v_perm_b32 v74, v111, v107, s56
    v_perm_b32 v78, v111, v107, s57
    v_perm_b32 v51, v116, v112, s56
    v_perm_b32 v55, v116, v112, s57
    v_perm_b32 v59, v117, v113, s56
    v_perm_b32 v63, v117, v113, s57
    v_perm_b32 v67, v118, v114, s56
    v_perm_b32 v71, v118, v114, s57
    v_perm_b32 v75, v119, v115, s56
    v_perm_b32 v79, v119, v115, s57
    s_waitcnt lgkmcnt(0)
    ds_read_b128 v[80:83], v7 offset:1536
    v_mfma_f32_16x16x32_bf16 v[16:19], v[84:87], v[48:51], v[16:19]
    v_mfma_f32_16x16x32_bf16 v[20:23], v[84:87], v[52:55], v[20:23]
    v_mfma_f32_16x16x32_bf16 v[24:27], v[84:87], v[56:59], v[24:27]
    v_mfma_f32_16x16x32_bf16 v[28:31], v[84:87], v[60:63], v[28:31]
    v_mfma_f32_16x16x32_bf16 v[32:35], v[84:87], v[64:67], v[32:35]
    v_mfma_f32_16x16x32_bf16 v[36:39], v[84:87], v[68:71], v[36:39]
    v_mfma_f32_16x16x32_bf16 v[40:43], v[84:87], v[72:75], v[40:43]
    v_mfma_f32_16x16x32_bf16 v[44:47], v[84:87], v[76:79], v[44:47]
    s_waitcnt vmcnt(5)
    s_mov_b32 s48, 229376
    buffer_load_dwordx4 v[152:155], v5, s[40:43], s48 offen offset:0 nt
    v_perm_b32 v48, v124, v120, s56
    v_perm_b32 v52, v124, v120, s57
    v_perm_b32 v56, v125, v121, s56
    v_perm_b32 v60, v125, v121, s57
    v_perm_b32 v64, v126, v122, s56
    v_perm_b32 v68, v126, v122, s57
    v_perm_b32 v72, v127, v123, s56
    v_perm_b32 v76, v127, v123, s57
    s_waitcnt vmcnt(5)
    buffer_load_dwordx4 v[156:159], v5, s[40:43], s48 offen offset:1024 nt
    v_perm_b32 v49, v132, v128, s56
    v_perm_b32 v53, v132, v128, s57
    v_perm_b32 v57, v133, v129, s56
    v_perm_b32 v61, v133, v129, s57
    v_perm_b32 v65, v134, v130, s56
    v_perm_b32 v69, v134, v130, s57
    v_perm_b32 v73, v135, v131, s56
    v_perm_b32 v77, v135, v131, s57
    s_waitcnt vmcnt(5)
    buffer_load_dwordx4 v[160:163], v5, s[40:43], s48 offen offset:2048 nt
    s_waitcnt vmcnt(5)
    buffer_load_dwordx4 v[164:167], v5, s[40:43], s48 offen offset:3072 nt
    v_perm_b32 v50, v140, v136, s56
    v_perm_b32 v54, v140, v136, s57
    v_perm_b32 v58, v141, v137, s56
    v_perm_b32 v62, v141, v137, s57
    v_perm_b32 v66, v142, v138, s56
    v_perm_b32 v70, v142, v138, s57
    v_perm_b32 v74, v143, v139, s56
    v_perm_b32 v78, v143, v139, s57
    s_waitcnt vmcnt(5)
    s_mov_b32 s48, 233472
    buffer_load_dwordx4 v[168:171], v5, s[40:43], s48 offen offset:0 nt
    s_waitcnt vmcnt(5)
    buffer_load_dwordx4 v[172:175], v5, s[40:43], s48 offen offset:1024 nt
    v_perm_b32 v51, v148, v144, s56
    v_perm_b32 v55, v148, v144, s57
    v_perm_b32 v59, v149, v145, s56
    v_perm_b32 v63, v149, v145, s57
    v_perm_b32 v67, v150, v146, s56
    v_perm_b32 v71, v150, v146, s57
    v_perm_b32 v75, v151, v147, s56
    v_perm_b32 v79, v151, v147, s57
    s_waitcnt lgkmcnt(0)
    ds_read_b128 v[84:87], v7 offset:1792
    v_mfma_f32_16x16x32_bf16 v[16:19], v[80:83], v[48:51], v[16:19]
    v_mfma_f32_16x16x32_bf16 v[20:23], v[80:83], v[52:55], v[20:23]
    v_mfma_f32_16x16x32_bf16 v[24:27], v[80:83], v[56:59], v[24:27]
    v_mfma_f32_16x16x32_bf16 v[28:31], v[80:83], v[60:63], v[28:31]
    v_mfma_f32_16x16x32_bf16 v[32:35], v[80:83], v[64:67], v[32:35]
    v_mfma_f32_16x16x32_bf16 v[36:39], v[80:83], v[68:71], v[36:39]
    v_mfma_f32_16x16x32_bf16 v[40:43], v[80:83], v[72:75], v[40:43]
    v_mfma_f32_16x16x32_bf16 v[44:47], v[80:83], v[76:79], v[44:47]
    s_waitcnt vmcnt(5)
    buffer_load_dwordx4 v[176:179], v5, s[40:43], s48 offen offset:2048 nt
    s_waitcnt vmcnt(5)
    buffer_load_dwordx4 v[180:183], v5, s[40:43], s48 offen offset:3072 nt
    v_perm_b32 v48, v156, v152, s56
    v_perm_b32 v52, v156, v152, s57
    v_perm_b32 v56, v157, v153, s56
    v_perm_b32 v60, v157, v153, s57
    v_perm_b32 v64, v158, v154, s56
    v_perm_b32 v68, v158, v154, s57
    v_perm_b32 v72, v159, v155, s56
    v_perm_b32 v76, v159, v155, s57
    s_waitcnt vmcnt(5)
    s_mov_b32 s48, 262144
    buffer_load_dwordx4 v[184:187], v5, s[40:43], s48 offen offset:0 nt
    s_waitcnt vmcnt(5)
    buffer_load_dwordx4 v[188:191], v5, s[40:43], s48 offen offset:1024 nt
    v_perm_b32 v49, v164, v160, s56
    v_perm_b32 v53, v164, v160, s57
    v_perm_b32 v57, v165, v161, s56
    v_perm_b32 v61, v165, v161, s57
    v_perm_b32 v65, v166, v162, s56
    v_perm_b32 v69, v166, v162, s57
    v_perm_b32 v73, v167, v163, s56
    v_perm_b32 v77, v167, v163, s57
    s_waitcnt vmcnt(5)
    buffer_load_dwordx4 v[192:195], v5, s[40:43], s48 offen offset:2048 nt
    s_waitcnt vmcnt(5)
    buffer_load_dwordx4 v[196:199], v5, s[40:43], s48 offen offset:3072 nt
    v_perm_b32 v50, v172, v168, s56
    v_perm_b32 v54, v172, v168, s57
    v_perm_b32 v58, v173, v169, s56
    v_perm_b32 v62, v173, v169, s57
    v_perm_b32 v66, v174, v170, s56
    v_perm_b32 v70, v174, v170, s57
    v_perm_b32 v74, v175, v171, s56
    v_perm_b32 v78, v175, v171, s57
    s_waitcnt vmcnt(5)
    s_mov_b32 s48, 266240
    buffer_load_dwordx4 v[200:203], v5, s[40:43], s48 offen offset:0 nt
    s_waitcnt vmcnt(5)
    buffer_load_dwordx4 v[204:207], v5, s[40:43], s48 offen offset:1024 nt
    v_perm_b32 v51, v180, v176, s56
    v_perm_b32 v55, v180, v176, s57
    v_perm_b32 v59, v181, v177, s56
    v_perm_b32 v63, v181, v177, s57
    v_perm_b32 v67, v182, v178, s56
    v_perm_b32 v71, v182, v178, s57
    v_perm_b32 v75, v183, v179, s56
    v_perm_b32 v79, v183, v179, s57
    s_waitcnt lgkmcnt(0)
    ds_read_b128 v[80:83], v7 offset:2048
    v_mfma_f32_16x16x32_bf16 v[16:19], v[84:87], v[48:51], v[16:19]
    v_mfma_f32_16x16x32_bf16 v[20:23], v[84:87], v[52:55], v[20:23]
    v_mfma_f32_16x16x32_bf16 v[24:27], v[84:87], v[56:59], v[24:27]
    v_mfma_f32_16x16x32_bf16 v[28:31], v[84:87], v[60:63], v[28:31]
    v_mfma_f32_16x16x32_bf16 v[32:35], v[84:87], v[64:67], v[32:35]
    v_mfma_f32_16x16x32_bf16 v[36:39], v[84:87], v[68:71], v[36:39]
    v_mfma_f32_16x16x32_bf16 v[40:43], v[84:87], v[72:75], v[40:43]
    v_mfma_f32_16x16x32_bf16 v[44:47], v[84:87], v[76:79], v[44:47]
    s_waitcnt vmcnt(5)
    buffer_load_dwordx4 v[208:211], v5, s[40:43], s48 offen offset:2048 nt
    s_waitcnt vmcnt(5)
    buffer_load_dwordx4 v[212:215], v5, s[40:43], s48 offen offset:3072 nt
    v_perm_b32 v48, v188, v184, s56
    v_perm_b32 v52, v188, v184, s57
    v_perm_b32 v56, v189, v185, s56
    v_perm_b32 v60, v189, v185, s57
    v_perm_b32 v64, v190, v186, s56
    v_perm_b32 v68, v190, v186, s57
    v_perm_b32 v72, v191, v187, s56
    v_perm_b32 v76, v191, v187, s57
    s_waitcnt vmcnt(5)
    s_add_u32 s48, s49, 0
    s_mov_b64 exec, s[52:53]
    buffer_load_dwordx4 v[216:219], v9, s[44:47], s48 offen offset:0
    s_mov_b64 exec, -1
    s_waitcnt vmcnt(5)
    s_add_u32 s48, s49, 0
    s_mov_b64 exec, s[52:53]
    buffer_load_dwordx4 v[220:223], v9, s[44:47], s48 offen offset:896
    s_mov_b64 exec, -1
    v_perm_b32 v49, v196, v192, s56
    v_perm_b32 v53, v196, v192, s57
    v_perm_b32 v57, v197, v193, s56
    v_perm_b32 v61, v197, v193, s57
    v_perm_b32 v65, v198, v194, s56
    v_perm_b32 v69, v198, v194, s57
    v_perm_b32 v73, v199, v195, s56
    v_perm_b32 v77, v199, v195, s57
    s_waitcnt vmcnt(5)
    s_add_u32 s48, s49, 0
    s_mov_b64 exec, s[52:53]
    buffer_load_dwordx4 v[224:227], v9, s[44:47], s48 offen offset:1792
    s_mov_b64 exec, -1
    s_waitcnt vmcnt(5)
    s_add_u32 s48, s49, 0
    s_mov_b64 exec, s[52:53]
    buffer_load_dwordx4 v[228:231], v9, s[44:47], s48 offen offset:2688
    s_mov_b64 exec, -1
    v_perm_b32 v50, v204, v200, s56
    v_perm_b32 v54, v204, v200, s57
    v_perm_b32 v58, v205, v201, s56
    v_perm_b32 v62, v205, v201, s57
    v_perm_b32 v66, v206, v202, s56
    v_perm_b32 v70, v206, v202, s57
    v_perm_b32 v74, v207, v203, s56
    v_perm_b32 v78, v207, v203, s57
    s_waitcnt vmcnt(5)
    s_add_u32 s48, s49, 3584
    s_mov_b64 exec, s[52:53]
    buffer_load_dwordx4 v[232:235], v9, s[44:47], s48 offen offset:0
    s_mov_b64 exec, -1
    s_waitcnt vmcnt(5)
    s_add_u32 s48, s49, 3584
    s_mov_b64 exec, s[52:53]
    buffer_load_dwordx4 v[236:239], v9, s[44:47], s48 offen offset:896
    s_mov_b64 exec, -1
    v_perm_b32 v51, v212, v208, s56
    v_perm_b32 v55, v212, v208, s57
    v_perm_b32 v59, v213, v209, s56
    v_perm_b32 v63, v213, v209, s57
    v_perm_b32 v67, v214, v210, s56
    v_perm_b32 v71, v214, v210, s57
    v_perm_b32 v75, v215, v211, s56
    v_perm_b32 v79, v215, v211, s57
    s_waitcnt lgkmcnt(0)
    ds_read_b128 v[84:87], v7 offset:2304
    v_mfma_f32_16x16x32_bf16 v[16:19], v[80:83], v[48:51], v[16:19]
    v_mfma_f32_16x16x32_bf16 v[20:23], v[80:83], v[52:55], v[20:23]
    v_mfma_f32_16x16x32_bf16 v[24:27], v[80:83], v[56:59], v[24:27]
    v_mfma_f32_16x16x32_bf16 v[28:31], v[80:83], v[60:63], v[28:31]
    v_mfma_f32_16x16x32_bf16 v[32:35], v[80:83], v[64:67], v[32:35]
    v_mfma_f32_16x16x32_bf16 v[36:39], v[80:83], v[68:71], v[36:39]
    v_mfma_f32_16x16x32_bf16 v[40:43], v[80:83], v[72:75], v[40:43]
    v_mfma_f32_16x16x32_bf16 v[44:47], v[80:83], v[76:79], v[44:47]
    s_waitcnt vmcnt(5)
    s_add_u32 s48, s49, 3584
    s_mov_b64 exec, s[52:53]
    buffer_load_dwordx4 v[240:243], v9, s[44:47], s48 offen offset:1792
    s_mov_b64 exec, -1
    s_waitcnt vmcnt(5)
    s_add_u32 s48, s49, 3584
    s_mov_b64 exec, s[52:53]
    buffer_load_dwordx4 v[244:247], v9, s[44:47], s48 offen offset:2688
    s_mov_b64 exec, -1
    v_perm_b32 v212, v220, v216, s56
    v_perm_b32 v208, v220, v216, s57
    v_perm_b32 v204, v221, v217, s56
    v_perm_b32 v200, v221, v217, s57
    v_perm_b32 v196, v222, v218, s56
    v_perm_b32 v192, v222, v218, s57
    v_perm_b32 v188, v223, v219, s56
    v_perm_b32 v184, v223, v219, s57
    s_waitcnt vmcnt(5)
    s_mov_b32 s48, 294912
    buffer_load_dwordx4 v[248:251], v5, s[40:43], s48 offen offset:0 nt
    s_waitcnt vmcnt(5)
    buffer_load_dwordx4 v[252:255], v5, s[40:43], s48 offen offset:1024 nt
    v_perm_b32 v213, v228, v224, s56
    v_perm_b32 v209, v228, v224, s57
    v_perm_b32 v205, v229, v225, s56
    v_perm_b32 v201, v229, v225, s57
    v_perm_b32 v197, v230, v226, s56
    v_perm_b32 v193, v230, v226, s57
    v_perm_b32 v189, v231, v227, s56
    v_perm_b32 v185, v231, v227, s57
    s_waitcnt vmcnt(5)
    buffer_load_dwordx4 v[88:91], v5, s[40:43], s48 offen offset:2048 nt
    s_waitcnt vmcnt(5)
    buffer_load_dwordx4 v[92:95], v5, s[40:43], s48 offen offset:3072 nt
    v_perm_b32 v214, v236, v232, s56
    v_perm_b32 v210, v236, v232, s57
    v_perm_b32 v206, v237, v233, s56
    v_perm_b32 v202, v237, v233, s57
    v_perm_b32 v198, v238, v234, s56
    v_perm_b32 v194, v238, v234, s57
    v_perm_b32 v190, v239, v235, s56
    v_perm_b32 v186, v239, v235, s57
    s_waitcnt vmcnt(5)
    s_mov_b32 s48, 299008
    buffer_load_dwordx4 v[96:99], v5, s[40:43], s48 offen offset:0 nt
    s_waitcnt vmcnt(5)
    buffer_load_dwordx4 v[100:103], v5, s[40:43], s48 offen offset:1024 nt
    v_perm_b32 v215, v244, v240, s56
    v_perm_b32 v211, v244, v240, s57
    v_perm_b32 v207, v245, v241, s56
    v_perm_b32 v203, v245, v241, s57
    v_perm_b32 v199, v246, v242, s56
    v_perm_b32 v195, v246, v242, s57
    v_perm_b32 v191, v247, v243, s56
    v_perm_b32 v187, v247, v243, s57
    s_waitcnt vmcnt(5)
    buffer_load_dwordx4 v[104:107], v5, s[40:43], s48 offen offset:2048 nt
    s_waitcnt vmcnt(5)
    buffer_load_dwordx4 v[108:111], v5, s[40:43], s48 offen offset:3072 nt
    v_perm_b32 v48, v252, v248, s56
    v_perm_b32 v52, v252, v248, s57
    v_perm_b32 v56, v253, v249, s56
    v_perm_b32 v60, v253, v249, s57
    v_perm_b32 v64, v254, v250, s56
    v_perm_b32 v68, v254, v250, s57
    v_perm_b32 v72, v255, v251, s56
    v_perm_b32 v76, v255, v251, s57
    s_waitcnt vmcnt(5)
    s_add_u32 s48, s49, 28672
    s_mov_b64 exec, s[52:53]
    buffer_load_dwordx4 v[112:115], v9, s[44:47], s48 offen offset:0
    s_mov_b64 exec, -1
    s_waitcnt vmcnt(5)
    s_add_u32 s48, s49, 28672
    s_mov_b64 exec, s[52:53]
    buffer_load_dwordx4 v[116:119], v9, s[44:47], s48 offen offset:896
    s_mov_b64 exec, -1
    v_perm_b32 v49, v92, v88, s56
    v_perm_b32 v53, v92, v88, s57
    v_perm_b32 v57, v93, v89, s56
    v_perm_b32 v61, v93, v89, s57
    v_perm_b32 v65, v94, v90, s56
    v_perm_b32 v69, v94, v90, s57
    v_perm_b32 v73, v95, v91, s56
    v_perm_b32 v77, v95, v91, s57
    s_waitcnt vmcnt(5)
    s_add_u32 s48, s49, 28672
    s_mov_b64 exec, s[52:53]
    buffer_load_dwordx4 v[120:123], v9, s[44:47], s48 offen offset:1792
    s_mov_b64 exec, -1
    s_waitcnt vmcnt(5)
    s_add_u32 s48, s49, 28672
    s_mov_b64 exec, s[52:53]
    buffer_load_dwordx4 v[124:127], v9, s[44:47], s48 offen offset:2688
    s_mov_b64 exec, -1
    v_perm_b32 v50, v100, v96, s56
    v_perm_b32 v54, v100, v96, s57
    v_perm_b32 v58, v101, v97, s56
    v_perm_b32 v62, v101, v97, s57
    v_perm_b32 v66, v102, v98, s56
    v_perm_b32 v70, v102, v98, s57
    v_perm_b32 v74, v103, v99, s56
    v_perm_b32 v78, v103, v99, s57
    s_waitcnt vmcnt(5)
    s_add_u32 s48, s49, 32256
    s_mov_b64 exec, s[52:53]
    buffer_load_dwordx4 v[128:131], v9, s[44:47], s48 offen offset:0
    s_mov_b64 exec, -1
    s_waitcnt vmcnt(5)
    s_add_u32 s48, s49, 32256
    s_mov_b64 exec, s[52:53]
    buffer_load_dwordx4 v[132:135], v9, s[44:47], s48 offen offset:896
    s_mov_b64 exec, -1
    v_perm_b32 v51, v108, v104, s56
    v_perm_b32 v55, v108, v104, s57
    v_perm_b32 v59, v109, v105, s56
    v_perm_b32 v63, v109, v105, s57
    v_perm_b32 v67, v110, v106, s56
    v_perm_b32 v71, v110, v106, s57
    v_perm_b32 v75, v111, v107, s56
    v_perm_b32 v79, v111, v107, s57
    s_waitcnt lgkmcnt(0)
    ds_read_b128 v[80:83], v7 offset:2560
    v_mfma_f32_16x16x32_bf16 v[16:19], v[84:87], v[48:51], v[16:19]
    v_mfma_f32_16x16x32_bf16 v[20:23], v[84:87], v[52:55], v[20:23]
    v_mfma_f32_16x16x32_bf16 v[24:27], v[84:87], v[56:59], v[24:27]
    v_mfma_f32_16x16x32_bf16 v[28:31], v[84:87], v[60:63], v[28:31]
    v_mfma_f32_16x16x32_bf16 v[32:35], v[84:87], v[64:67], v[32:35]
    v_mfma_f32_16x16x32_bf16 v[36:39], v[84:87], v[68:71], v[36:39]
    v_mfma_f32_16x16x32_bf16 v[40:43], v[84:87], v[72:75], v[40:43]
    v_mfma_f32_16x16x32_bf16 v[44:47], v[84:87], v[76:79], v[44:47]
    s_waitcnt vmcnt(5)
    s_add_u32 s48, s49, 32256
    s_mov_b64 exec, s[52:53]
    buffer_load_dwordx4 v[136:139], v9, s[44:47], s48 offen offset:1792
    s_mov_b64 exec, -1
    s_waitcnt vmcnt(5)
    s_add_u32 s48, s49, 32256
    s_mov_b64 exec, s[52:53]
    buffer_load_dwordx4 v[140:143], v9, s[44:47], s48 offen offset:2688
    s_mov_b64 exec, -1
    v_perm_b32 v108, v116, v112, s56
    v_perm_b32 v104, v116, v112, s57
    v_perm_b32 v100, v117, v113, s56
    v_perm_b32 v96, v117, v113, s57
    v_perm_b32 v92, v118, v114, s56
    v_perm_b32 v88, v118, v114, s57
    v_perm_b32 v252, v119, v115, s56
    v_perm_b32 v248, v119, v115, s57
    s_waitcnt vmcnt(5)
    s_mov_b32 s48, 327680
    buffer_load_dwordx4 v[144:147], v5, s[40:43], s48 offen offset:0 nt
    s_waitcnt vmcnt(5)
    buffer_load_dwordx4 v[148:151], v5, s[40:43], s48 offen offset:1024 nt
    v_perm_b32 v109, v124, v120, s56
    v_perm_b32 v105, v124, v120, s57
    v_perm_b32 v101, v125, v121, s56
    v_perm_b32 v97, v125, v121, s57
    v_perm_b32 v93, v126, v122, s56
    v_perm_b32 v89, v126, v122, s57
    v_perm_b32 v253, v127, v123, s56
    v_perm_b32 v249, v127, v123, s57
    s_waitcnt vmcnt(5)
    buffer_load_dwordx4 v[152:155], v5, s[40:43], s48 offen offset:2048 nt
    s_waitcnt vmcnt(5)
    buffer_load_dwordx4 v[156:159], v5, s[40:43], s48 offen offset:3072 nt
    v_perm_b32 v110, v132, v128, s56
    v_perm_b32 v106, v132, v128, s57
    v_perm_b32 v102, v133, v129, s56
    v_perm_b32 v98, v133, v129, s57
    v_perm_b32 v94, v134, v130, s56
    v_perm_b32 v90, v134, v130, s57
    v_perm_b32 v254, v135, v131, s56
    v_perm_b32 v250, v135, v131, s57
    s_waitcnt vmcnt(5)
    s_mov_b32 s48, 331776
    buffer_load_dwordx4 v[160:163], v5, s[40:43], s48 offen offset:0 nt
    s_waitcnt vmcnt(5)
    buffer_load_dwordx4 v[164:167], v5, s[40:43], s48 offen offset:1024 nt
    v_perm_b32 v111, v140, v136, s56
    v_perm_b32 v107, v140, v136, s57
    v_perm_b32 v103, v141, v137, s56
    v_perm_b32 v99, v141, v137, s57
    v_perm_b32 v95, v142, v138, s56
    v_perm_b32 v91, v142, v138, s57
    v_perm_b32 v255, v143, v139, s56
    v_perm_b32 v251, v143, v139, s57
    s_waitcnt vmcnt(5)
    buffer_load_dwordx4 v[168:171], v5, s[40:43], s48 offen offset:2048 nt
    s_waitcnt vmcnt(5)
    buffer_load_dwordx4 v[172:175], v5, s[40:43], s48 offen offset:3072 nt
    v_perm_b32 v48, v148, v144, s56
    v_perm_b32 v52, v148, v144, s57
    v_perm_b32 v56, v149, v145, s56
    v_perm_b32 v60, v149, v145, s57
    v_perm_b32 v64, v150, v146, s56
    v_perm_b32 v68, v150, v146, s57
    v_perm_b32 v72, v151, v147, s56
    v_perm_b32 v76, v151, v147, s57
    s_waitcnt vmcnt(5)
    s_mov_b32 s48, 360448
    buffer_load_dwordx4 v[176:179], v5, s[40:43], s48 offen offset:0 nt
    s_waitcnt vmcnt(5)
    buffer_load_dwordx4 v[180:183], v5, s[40:43], s48 offen offset:1024 nt
    v_perm_b32 v49, v156, v152, s56
    v_perm_b32 v53, v156, v152, s57
    v_perm_b32 v57, v157, v153, s56
    v_perm_b32 v61, v157, v153, s57
    v_perm_b32 v65, v158, v154, s56
    v_perm_b32 v69, v158, v154, s57
    v_perm_b32 v73, v159, v155, s56
    v_perm_b32 v77, v159, v155, s57
    s_waitcnt vmcnt(5)
    buffer_load_dwordx4 v[216:219], v5, s[40:43], s48 offen offset:2048 nt
    s_waitcnt vmcnt(5)
    buffer_load_dwordx4 v[220:223], v5, s[40:43], s48 offen offset:3072 nt
    v_perm_b32 v50, v164, v160, s56
    v_perm_b32 v54, v164, v160, s57
    v_perm_b32 v58, v165, v161, s56
    v_perm_b32 v62, v165, v161, s57
    v_perm_b32 v66, v166, v162, s56
    v_perm_b32 v70, v166, v162, s57
    v_perm_b32 v74, v167, v163, s56
    v_perm_b32 v78, v167, v163, s57
    s_waitcnt vmcnt(5)
    s_mov_b32 s48, 364544
    buffer_load_dwordx4 v[224:227], v5, s[40:43], s48 offen offset:0 nt
    s_waitcnt vmcnt(5)
    buffer_load_dwordx4 v[228:231], v5, s[40:43], s48 offen offset:1024 nt
    v_perm_b32 v51, v172, v168, s56
    v_perm_b32 v55, v172, v168, s57
    v_perm_b32 v59, v173, v169, s56
    v_perm_b32 v63, v173, v169, s57
    v_perm_b32 v67, v174, v170, s56
    v_perm_b32 v71, v174, v170, s57
    v_perm_b32 v75, v175, v171, s56
    v_perm_b32 v79, v175, v171, s57
    s_waitcnt lgkmcnt(0)
    ds_read_b128 v[84:87], v7 offset:2816
    v_mfma_f32_16x16x32_bf16 v[16:19], v[80:83], v[48:51], v[16:19]
    v_mfma_f32_16x16x32_bf16 v[20:23], v[80:83], v[52:55], v[20:23]
    v_mfma_f32_16x16x32_bf16 v[24:27], v[80:83], v[56:59], v[24:27]
    v_mfma_f32_16x16x32_bf16 v[28:31], v[80:83], v[60:63], v[28:31]
    v_mfma_f32_16x16x32_bf16 v[32:35], v[80:83], v[64:67], v[32:35]
    v_mfma_f32_16x16x32_bf16 v[36:39], v[80:83], v[68:71], v[36:39]
    v_mfma_f32_16x16x32_bf16 v[40:43], v[80:83], v[72:75], v[40:43]
    v_mfma_f32_16x16x32_bf16 v[44:47], v[80:83], v[76:79], v[44:47]
    s_waitcnt vmcnt(5)
    buffer_load_dwordx4 v[232:235], v5, s[40:43], s48 offen offset:2048 nt
    s_waitcnt vmcnt(5)
    buffer_load_dwordx4 v[236:239], v5, s[40:43], s48 offen offset:3072 nt
    v_perm_b32 v48, v180, v176, s56
    v_perm_b32 v52, v180, v176, s57
    v_perm_b32 v56, v181, v177, s56
    v_perm_b32 v60, v181, v177, s57
    v_perm_b32 v64, v182, v178, s56
    v_perm_b32 v68, v182, v178, s57
    v_perm_b32 v72, v183, v179, s56
    v_perm_b32 v76, v183, v179, s57
    s_waitcnt vmcnt(5)
    s_mov_b32 s48, 393216
    buffer_load_dwordx4 v[240:243], v5, s[40:43], s48 offen offset:0 nt
    s_waitcnt vmcnt(5)
    buffer_load_dwordx4 v[244:247], v5, s[40:43], s48 offen offset:1024 nt
    v_perm_b32 v49, v220, v216, s56
    v_perm_b32 v53, v220, v216, s57
    v_perm_b32 v57, v221, v217, s56
    v_perm_b32 v61, v221, v217, s57
    v_perm_b32 v65, v222, v218, s56
    v_perm_b32 v69, v222, v218, s57
    v_perm_b32 v73, v223, v219, s56
    v_perm_b32 v77, v223, v219, s57
    s_waitcnt vmcnt(5)
    buffer_load_dwordx4 v[112:115], v5, s[40:43], s48 offen offset:2048 nt
    s_waitcnt vmcnt(5)
    buffer_load_dwordx4 v[116:119], v5, s[40:43], s48 offen offset:3072 nt
    v_perm_b32 v50, v228, v224, s56
    v_perm_b32 v54, v228, v224, s57
    v_perm_b32 v58, v229, v225, s56
    v_perm_b32 v62, v229, v225, s57
    v_perm_b32 v66, v230, v226, s56
    v_perm_b32 v70, v230, v226, s57
    v_perm_b32 v74, v231, v227, s56
    v_perm_b32 v78, v231, v227, s57
    s_waitcnt vmcnt(5)
    s_mov_b32 s48, 397312
    buffer_load_dwordx4 v[120:123], v5, s[40:43], s48 offen offset:0 nt
    s_waitcnt vmcnt(5)
    buffer_load_dwordx4 v[124:127], v5, s[40:43], s48 offen offset:1024 nt
    v_perm_b32 v51, v236, v232, s56
    v_perm_b32 v55, v236, v232, s57
    v_perm_b32 v59, v237, v233, s56
    v_perm_b32 v63, v237, v233, s57
    v_perm_b32 v67, v238, v234, s56
    v_perm_b32 v71, v238, v234, s57
    v_perm_b32 v75, v239, v235, s56
    v_perm_b32 v79, v239, v235, s57
    s_waitcnt lgkmcnt(0)
    ds_read_b128 v[80:83], v7 offset:3072
    v_mfma_f32_16x16x32_bf16 v[16:19], v[84:87], v[48:51], v[16:19]
    v_mfma_f32_16x16x32_bf16 v[20:23], v[84:87], v[52:55], v[20:23]
    v_mfma_f32_16x16x32_bf16 v[24:27], v[84:87], v[56:59], v[24:27]
    v_mfma_f32_16x16x32_bf16 v[28:31], v[84:87], v[60:63], v[28:31]
    v_mfma_f32_16x16x32_bf16 v[32:35], v[84:87], v[64:67], v[32:35]
    v_mfma_f32_16x16x32_bf16 v[36:39], v[84:87], v[68:71], v[36:39]
    v_mfma_f32_16x16x32_bf16 v[40:43], v[84:87], v[72:75], v[40:43]
    v_mfma_f32_16x16x32_bf16 v[44:47], v[84:87], v[76:79], v[44:47]
    s_waitcnt vmcnt(5)
    buffer_load_dwordx4 v[128:131], v5, s[40:43], s48 offen offset:2048 nt
    s_waitcnt vmcnt(5)
    buffer_load_dwordx4 v[132:135], v5, s[40:43], s48 offen offset:3072 nt
    v_perm_b32 v48, v244, v240, s56
    v_perm_b32 v52, v244, v240, s57
    v_perm_b32 v56, v245, v241, s56
    v_perm_b32 v60, v245, v241, s57
    v_perm_b32 v64, v246, v242, s56
    v_perm_b32 v68, v246, v242, s57
    v_perm_b32 v72, v247, v243, s56
    v_perm_b32 v76, v247, v243, s57
    s_waitcnt vmcnt(5)
    s_mov_b32 s48, 425984
    buffer_load_dwordx4 v[136:139], v5, s[40:43], s48 offen offset:0 nt
    s_waitcnt vmcnt(5)
    buffer_load_dwordx4 v[140:143], v5, s[40:43], s48 offen offset:1024 nt
    v_perm_b32 v49, v116, v112, s56
    v_perm_b32 v53, v116, v112, s57
    v_perm_b32 v57, v117, v113, s56
    v_perm_b32 v61, v117, v113, s57
    v_perm_b32 v65, v118, v114, s56
    v_perm_b32 v69, v118, v114, s57
    v_perm_b32 v73, v119, v115, s56
    v_perm_b32 v77, v119, v115, s57
    s_waitcnt vmcnt(5)
    buffer_load_dwordx4 v[144:147], v5, s[40:43], s48 offen offset:2048 nt
    s_waitcnt vmcnt(5)
    buffer_load_dwordx4 v[148:151], v5, s[40:43], s48 offen offset:3072 nt
    v_perm_b32 v50, v124, v120, s56
    v_perm_b32 v54, v124, v120, s57
    v_perm_b32 v58, v125, v121, s56
    v_perm_b32 v62, v125, v121, s57
    v_perm_b32 v66, v126, v122, s56
    v_perm_b32 v70, v126, v122, s57
    v_perm_b32 v74, v127, v123, s56
    v_perm_b32 v78, v127, v123, s57
    s_waitcnt vmcnt(5)
    s_mov_b32 s48, 430080
    buffer_load_dwordx4 v[152:155], v5, s[40:43], s48 offen offset:0 nt
    s_waitcnt vmcnt(5)
    buffer_load_dwordx4 v[156:159], v5, s[40:43], s48 offen offset:1024 nt
    v_perm_b32 v51, v132, v128, s56
    v_perm_b32 v55, v132, v128, s57
    v_perm_b32 v59, v133, v129, s56
    v_perm_b32 v63, v133, v129, s57
    v_perm_b32 v67, v134, v130, s56
    v_perm_b32 v71, v134, v130, s57
    v_perm_b32 v75, v135, v131, s56
    v_perm_b32 v79, v135, v131, s57
    s_waitcnt lgkmcnt(0)
    ds_read_b128 v[84:87], v7 offset:3328
    v_mfma_f32_16x16x32_bf16 v[16:19], v[80:83], v[48:51], v[16:19]
    v_mfma_f32_16x16x32_bf16 v[20:23], v[80:83], v[52:55], v[20:23]
    v_mfma_f32_16x16x32_bf16 v[24:27], v[80:83], v[56:59], v[24:27]
    v_mfma_f32_16x16x32_bf16 v[28:31], v[80:83], v[60:63], v[28:31]
    v_mfma_f32_16x16x32_bf16 v[32:35], v[80:83], v[64:67], v[32:35]
    v_mfma_f32_16x16x32_bf16 v[36:39], v[80:83], v[68:71], v[36:39]
    v_mfma_f32_16x16x32_bf16 v[40:43], v[80:83], v[72:75], v[40:43]
    v_mfma_f32_16x16x32_bf16 v[44:47], v[80:83], v[76:79], v[44:47]
    buffer_load_dwordx4 v[160:163], v5, s[40:43], s48 offen offset:2048 nt
    buffer_load_dwordx4 v[164:167], v5, s[40:43], s48 offen offset:3072 nt
    s_mov_b32 s48, 458752
    buffer_load_dwordx4 v[168:171], v5, s[40:43], s48 offen offset:0 nt
    s_waitcnt vmcnt(8)
    buffer_load_dwordx4 v[172:175], v5, s[40:43], s48 offen offset:1024 nt
    s_waitcnt vmcnt(8)
    buffer_load_dwordx4 v[176:179], v5, s[40:43], s48 offen offset:2048 nt
    v_perm_b32 v48, v140, v136, s56
    v_perm_b32 v52, v140, v136, s57
    v_perm_b32 v56, v141, v137, s56
    v_perm_b32 v60, v141, v137, s57
    v_perm_b32 v64, v142, v138, s56
    v_perm_b32 v68, v142, v138, s57
    v_perm_b32 v72, v143, v139, s56
    v_perm_b32 v76, v143, v139, s57
    s_waitcnt vmcnt(8)
    buffer_load_dwordx4 v[180:183], v5, s[40:43], s48 offen offset:3072 nt
    s_waitcnt vmcnt(8)
    s_mov_b32 s48, 462848
    buffer_load_dwordx4 v[216:219], v5, s[40:43], s48 offen offset:0 nt
    v_perm_b32 v49, v148, v144, s56
    v_perm_b32 v53, v148, v144, s57
    v_perm_b32 v57, v149, v145, s56
    v_perm_b32 v61, v149, v145, s57
    v_perm_b32 v65, v150, v146, s56
    v_perm_b32 v69, v150, v146, s57
    v_perm_b32 v73, v151, v147, s56
    v_perm_b32 v77, v151, v147, s57
    s_waitcnt vmcnt(8)
    buffer_load_dwordx4 v[220:223], v5, s[40:43], s48 offen offset:1024 nt
    s_waitcnt vmcnt(8)
    buffer_load_dwordx4 v[224:227], v5, s[40:43], s48 offen offset:2048 nt
    v_perm_b32 v50, v156, v152, s56
    v_perm_b32 v54, v156, v152, s57
    v_perm_b32 v58, v157, v153, s56
    v_perm_b32 v62, v157, v153, s57
    v_perm_b32 v66, v158, v154, s56
    v_perm_b32 v70, v158, v154, s57
    v_perm_b32 v74, v159, v155, s56
    v_perm_b32 v78, v159, v155, s57
    s_waitcnt vmcnt(8)
    buffer_load_dwordx4 v[228:231], v5, s[40:43], s48 offen offset:3072 nt
    s_waitcnt vmcnt(8)
    s_mov_b32 s48, 491520
    buffer_load_dwordx4 v[232:235], v5, s[40:43], s48 offen offset:0 nt
    v_perm_b32 v51, v164, v160, s56
    v_perm_b32 v55, v164, v160, s57
    v_perm_b32 v59, v165, v161, s56
    v_perm_b32 v63, v165, v161, s57
    v_perm_b32 v67, v166, v162, s56
    v_perm_b32 v71, v166, v162, s57
    v_perm_b32 v75, v167, v163, s56
    v_perm_b32 v79, v167, v163, s57
    s_waitcnt lgkmcnt(0)
    ds_read_b128 v[80:83], v7 offset:3584
    v_mfma_f32_16x16x32_bf16 v[16:19], v[84:87], v[48:51], v[16:19]
    v_mfma_f32_16x16x32_bf16 v[20:23], v[84:87], v[52:55], v[20:23]
    v_mfma_f32_16x16x32_bf16 v[24:27], v[84:87], v[56:59], v[24:27]
    v_mfma_f32_16x16x32_bf16 v[28:31], v[84:87], v[60:63], v[28:31]
    v_mfma_f32_16x16x32_bf16 v[32:35], v[84:87], v[64:67], v[32:35]
    v_mfma_f32_16x16x32_bf16 v[36:39], v[84:87], v[68:71], v[36:39]
    v_mfma_f32_16x16x32_bf16 v[40:43], v[84:87], v[72:75], v[40:43]
    v_mfma_f32_16x16x32_bf16 v[44:47], v[84:87], v[76:79], v[44:47]
    s_waitcnt vmcnt(8)
    buffer_load_dwordx4 v[236:239], v5, s[40:43], s48 offen offset:1024 nt
    s_waitcnt vmcnt(8)
    buffer_load_dwordx4 v[240:243], v5, s[40:43], s48 offen offset:2048 nt
    v_perm_b32 v48, v172, v168, s56
    v_perm_b32 v52, v172, v168, s57
    v_perm_b32 v56, v173, v169, s56
    v_perm_b32 v60, v173, v169, s57
    v_perm_b32 v64, v174, v170, s56
    v_perm_b32 v68, v174, v170, s57
    v_perm_b32 v72, v175, v171, s56
    v_perm_b32 v76, v175, v171, s57
    s_waitcnt vmcnt(8)
    buffer_load_dwordx4 v[244:247], v5, s[40:43], s48 offen offset:3072 nt
    s_waitcnt vmcnt(8)
    s_mov_b32 s48, 495616
    buffer_load_dwordx4 v[112:115], v5, s[40:43], s48 offen offset:0 nt
    v_perm_b32 v49, v180, v176, s56
    v_perm_b32 v53, v180, v176, s57
    v_perm_b32 v57, v181, v177, s56
    v_perm_b32 v61, v181, v177, s57
    v_perm_b32 v65, v182, v178, s56
    v_perm_b32 v69, v182, v178, s57
    v_perm_b32 v73, v183, v179, s56
    v_perm_b32 v77, v183, v179, s57
    s_waitcnt vmcnt(8)
    buffer_load_dwordx4 v[116:119], v5, s[40:43], s48 offen offset:1024 nt
    s_waitcnt vmcnt(8)
    buffer_load_dwordx4 v[120:123], v5, s[40:43], s48 offen offset:2048 nt
    v_perm_b32 v50, v220, v216, s56
    v_perm_b32 v54, v220, v216, s57
    v_perm_b32 v58, v221, v217, s56
    v_perm_b32 v62, v221, v217, s57
    v_perm_b32 v66, v222, v218, s56
    v_perm_b32 v70, v222, v218, s57
    v_perm_b32 v74, v223, v219, s56
    v_perm_b32 v78, v223, v219, s57
    s_waitcnt vmcnt(8)
    buffer_load_dwordx4 v[124:127], v5, s[40:43], s48 offen offset:3072 nt
    s_waitcnt vmcnt(8)
    v_perm_b32 v51, v228, v224, s56
    v_perm_b32 v55, v228, v224, s57
    v_perm_b32 v59, v229, v225, s56
    v_perm_b32 v63, v229, v225, s57
    v_perm_b32 v67, v230, v226, s56
    v_perm_b32 v71, v230, v226, s57
    v_perm_b32 v75, v231, v227, s56
    v_perm_b32 v79, v231, v227, s57
    s_waitcnt lgkmcnt(0)
    ds_read_b128 v[84:87], v7 offset:3840
    v_mfma_f32_16x16x32_bf16 v[16:19], v[80:83], v[48:51], v[16:19]
    v_mfma_f32_16x16x32_bf16 v[20:23], v[80:83], v[52:55], v[20:23]
    v_mfma_f32_16x16x32_bf16 v[24:27], v[80:83], v[56:59], v[24:27]
    v_mfma_f32_16x16x32_bf16 v[28:31], v[80:83], v[60:63], v[28:31]
    v_mfma_f32_16x16x32_bf16 v[32:35], v[80:83], v[64:67], v[32:35]
    v_mfma_f32_16x16x32_bf16 v[36:39], v[80:83], v[68:71], v[36:39]
    v_mfma_f32_16x16x32_bf16 v[40:43], v[80:83], v[72:75], v[40:43]
    v_mfma_f32_16x16x32_bf16 v[44:47], v[80:83], v[76:79], v[44:47]
    s_waitcnt vmcnt(6)
    v_perm_b32 v48, v236, v232, s56
    v_perm_b32 v52, v236, v232, s57
    v_perm_b32 v56, v237, v233, s56
    v_perm_b32 v60, v237, v233, s57
    v_perm_b32 v64, v238, v234, s56
    v_perm_b32 v68, v238, v234, s57
    v_perm_b32 v72, v239, v235, s56
    v_perm_b32 v76, v239, v235, s57
    s_waitcnt vmcnt(4)
    v_perm_b32 v49, v244, v240, s56
    v_perm_b32 v53, v244, v240, s57
    v_perm_b32 v57, v245, v241, s56
    v_perm_b32 v61, v245, v241, s57
    v_perm_b32 v65, v246, v242, s56
    v_perm_b32 v69, v246, v242, s57
    v_perm_b32 v73, v247, v243, s56
    v_perm_b32 v77, v247, v243, s57
    s_waitcnt vmcnt(2)
    v_perm_b32 v50, v116, v112, s56
    v_perm_b32 v54, v116, v112, s57
    v_perm_b32 v58, v117, v113, s56
    v_perm_b32 v62, v117, v113, s57
    v_perm_b32 v66, v118, v114, s56
    v_perm_b32 v70, v118, v114, s57
    v_perm_b32 v74, v119, v115, s56
    v_perm_b32 v78, v119, v115, s57
    s_waitcnt vmcnt(0)
    v_perm_b32 v51, v124, v120, s56
    v_perm_b32 v55, v124, v120, s57
    v_perm_b32 v59, v125, v121, s56
    v_perm_b32 v63, v125, v121, s57
    v_perm_b32 v67, v126, v122, s56
    v_perm_b32 v71, v126, v122, s57
    v_perm_b32 v75, v127, v123, s56
    v_perm_b32 v79, v127, v123, s57
    s_waitcnt lgkmcnt(0)
    v_mfma_f32_16x16x32_bf16 v[16:19], v[84:87], v[48:51], v[16:19]
    v_mfma_f32_16x16x32_bf16 v[20:23], v[84:87], v[52:55], v[20:23]
    v_mfma_f32_16x16x32_bf16 v[24:27], v[84:87], v[56:59], v[24:27]
    v_mfma_f32_16x16x32_bf16 v[28:31], v[84:87], v[60:63], v[28:31]
    v_mfma_f32_16x16x32_bf16 v[32:35], v[84:87], v[64:67], v[32:35]
    v_mfma_f32_16x16x32_bf16 v[36:39], v[84:87], v[68:71], v[36:39]
    v_mfma_f32_16x16x32_bf16 v[40:43], v[84:87], v[72:75], v[40:43]
    v_mfma_f32_16x16x32_bf16 v[44:47], v[84:87], v[76:79], v[44:47]
    v_and_b32 v10, 1, v3
    v_lshrrev_b32 v11, 1, v3
    v_lshlrev_b32 v10, 10, v10
    v_lshl_add_u32 v10, v11, 9, v10
    v_lshl_add_u32 v10, v2, 5, v10
    s_lshl_b32 s35, s3, 11
    v_add_u32 v10, s35, v10
    s_nop 2
    v_mov_b32 v48, v16
    v_mov_b32 v49, v20
    v_mov_b32 v50, v24
    v_mov_b32 v51, v28
    v_mov_b32 v52, v32
    v_mov_b32 v53, v36
    v_mov_b32 v54, v40
    v_mov_b32 v55, v44
    ds_write_b128 v10, v[48:51] offset:24576
    ds_write_b128 v10, v[52:55] offset:24592
    s_waitcnt lgkmcnt(0)
    s_barrier
    s_cmp_ge_u32 s3, 2
    s_cbranch_scc1 L_st_skip1
    s_lshl_b32 s35, s3, 10
    v_lshl_add_u32 v10, v0, 4, s35
    ds_read_b128 v[16:19], v10 offset:24576
    ds_read_b128 v[20:23], v10 offset:26624
    ds_read_b128 v[24:27], v10 offset:28672
    ds_read_b128 v[28:31], v10 offset:30720
    s_lshl_b32 s35, s7, 13
    s_add_u32 s35, s35, 589824
    s_add_u32 s35, s35, s98
    s_add_u32 s36, s32, s35
    s_addc_u32 s37, s33, 0
    s_mov_b32 s38, 8192
    s_mov_b32 s39, 0x20000
    s_lshl_b32 s48, s6, 11
    s_waitcnt lgkmcnt(0)
    v_pk_add_f32 v[16:17], v[16:17], v[20:21]
    v_pk_add_f32 v[24:25], v[24:25], v[28:29]
    v_pk_add_f32 v[18:19], v[18:19], v[22:23]
    v_pk_add_f32 v[26:27], v[26:27], v[30:31]
    v_pk_add_f32 v[16:17], v[16:17], v[24:25]
    v_pk_add_f32 v[18:19], v[18:19], v[26:27]
    s_cmp_lg_u32 s97, 0
    s_cbranch_scc1 L_st_far
    buffer_store_dwordx4 v[16:19], v10, s[36:39], s48 offen
    s_branch L_st_stored
L_st_far:
    buffer_store_dwordx4 v[16:19], v10, s[36:39], s48 offen sc1
L_st_stored:
    v_add_u32 v11, 0x1000, v10
    s_mov_b32 s50, 40000
L_st_oppoll:
    buffer_load_dwordx4 v[32:35], v10, s[36:39], 0 offen offset:0 sc1
    buffer_load_dwordx4 v[36:39], v10, s[36:39], 0 offen offset:2048 sc1
    buffer_load_dwordx4 v[40:43], v11, s[36:39], 0 offen offset:0 sc1
    buffer_load_dwordx4 v[44:47], v11, s[36:39], 0 offen offset:2048 sc1
    s_waitcnt vmcnt(2)
    v_pk_add_f32 v[32:33], v[32:33], v[36:37]
    v_pk_add_f32 v[34:35], v[34:35], v[38:39]
    s_waitcnt vmcnt(0)
    v_pk_add_f32 v[40:41], v[40:41], v[44:45]
    v_pk_add_f32 v[42:43], v[42:43], v[46:47]
    v_pk_add_f32 v[32:33], v[32:33], v[40:41]
    v_pk_add_f32 v[34:35], v[34:35], v[42:43]
    v_pk_add_f32 v[36:37], v[32:33], v[34:35]
    v_cmp_u_f32 vcc, v36, v37
    s_cbranch_vccz L_st_opok
    s_sub_u32 s50, s50, 1
    s_cmp_lg_u32 s50, 0
    s_cbranch_scc1 L_st_oppoll
L_st_opok:
    v_cvt_pk_bf16_f32 v12, v32, v33
    v_cvt_pk_bf16_f32 v13, v34, v35
    v_lshrrev_b32 v10, 1, v10
    ds_write_b64 v10, v[12:13] offset:32768
    s_waitcnt lgkmcnt(0)
L_st_skip1:
    s_barrier
    s_mov_b32 s36, s22
    s_mov_b32 s37, s23
    s_mov_b32 s38, 3584
    s_mov_b32 s39, 0x20000
    s_max_i32 s48, s34, 0
    s_lshl_b32 s48, s48, 7
    v_lshlrev_b32 v10, 1, v0
    buffer_load_ushort v14, v10, s[36:39], s48 offen
    s_barrier
    s_barrier
    s_barrier
    s_cmp_lt_i32 s34, 0
    s_cbranch_scc1 L_st_end
    v_lshlrev_b32 v10, 2, v0
    ds_read_b32 v16, v10 offset:38912
    ds_read_b32 v17, v10 offset:39168
    ds_read_b32 v18, v10 offset:39424
    ds_read_b32 v19, v10 offset:39680
    s_lshl_b32 s35, s3, 7
    s_add_u32 s35, s35, 39936
    v_lshl_add_u32 v11, v0, 1, s35
    v_lshl_add_u32 v12, v3, 4, s35
    s_waitcnt vmcnt(0) lgkmcnt(0)
    v_add_f32 v16, v16, v17
    v_add_f32 v18, v18, v19
    v_add_f32 v16, v16, v18
    v_lshlrev_b32 v14, 16, v14
    v_cvt_pk_bf16_f32 v16, v16, v16
    v_lshlrev_b32 v16, 16, v16
    v_add_f32 v16, v16, v14
    v_cvt_pk_bf16_f32 v16, v16, v16
    v_lshlrev_b32 v16, 16, v16
    v_max_f32 v16, 0, v16
    v_mul_f32 v16, v16, v16
    v_cvt_pk_bf16_f32 v16, v16, v16
    ds_write_b16 v11, v16
    s_waitcnt lgkmcnt(0)
    ds_read_b128 v[80:83], v12
    ds_read_b128 v[84:87], v12 offset:64
    s_lshl_b32 s35, s4, 5
    s_add_u32 s35, s35, s34
    s_mul_i32 s35, s35, 1792
    s_add_u32 s35, s35, 1245184
    s_add_u32 s35, s35, s98
    s_add_u32 s36, s32, s35
    s_addc_u32 s37, s33, 0
    s_mov_b32 s38, 1792
    s_mov_b32 s39, 0x20000
    s_lshl_b32 s35, s3, 9
    v_lshl_add_u32 v10, v2, 5, s35
    s_waitcnt lgkmcnt(0)
    v_mfma_f32_16x16x32_bf16 v[16:19], v[80:83], v[212:215], 0
    v_mfma_f32_16x16x32_bf16 v[20:23], v[80:83], v[208:211], 0
    v_mfma_f32_16x16x32_bf16 v[24:27], v[80:83], v[204:207], 0
    v_mfma_f32_16x16x32_bf16 v[28:31], v[80:83], v[200:203], 0
    v_mfma_f32_16x16x32_bf16 v[32:35], v[80:83], v[196:199], 0
    v_mfma_f32_16x16x32_bf16 v[36:39], v[80:83], v[192:195], 0
    v_mfma_f32_16x16x32_bf16 v[40:43], v[80:83], v[188:191], 0
    v_mfma_f32_16x16x32_bf16 v[44:47], v[80:83], v[184:187], 0
    v_mfma_f32_16x16x32_bf16 v[16:19], v[84:87], v[108:111], v[16:19]
    v_mfma_f32_16x16x32_bf16 v[20:23], v[84:87], v[104:107], v[20:23]
    v_mfma_f32_16x16x32_bf16 v[24:27], v[84:87], v[100:103], v[24:27]
    v_mfma_f32_16x16x32_bf16 v[28:31], v[84:87], v[96:99], v[28:31]
    v_mfma_f32_16x16x32_bf16 v[32:35], v[84:87], v[92:95], v[32:35]
    v_mfma_f32_16x16x32_bf16 v[36:39], v[84:87], v[88:91], v[36:39]
    v_mfma_f32_16x16x32_bf16 v[40:43], v[84:87], v[252:255], v[40:43]
    v_mfma_f32_16x16x32_bf16 v[44:47], v[84:87], v[248:251], v[44:47]
    s_nop 1
    v_min_u32 v48, -2, v16
    v_min_u32 v49, -2, v20
    v_min_u32 v50, -2, v24
    v_min_u32 v51, -2, v28
    v_min_u32 v52, -2, v32
    v_min_u32 v53, -2, v36
    v_min_u32 v54, -2, v40
    v_min_u32 v55, -2, v44
    s_mov_b64 exec, 0xffff
    buffer_store_dwordx4 v[48:51], v10, s[36:39], 0 offen sc1
    buffer_store_dwordx4 v[52:55], v10, s[36:39], 0 offen offset:16 sc1
    s_mov_b64 exec, -1
L_st_end:
    s_endpgm
L_service:
    s_sub_u32 s35, s3, 4
    v_cmp_gt_u32 s[52:53], 56, v0
    v_lshlrev_b32 v4, 4, v0
    v_mov_b32 v5, 40448
    v_mov_b32 v8, 0
    v_mov_b32 v9, 0
    v_mov_b32 v10, 0
    v_mov_b32 v11, 0
    s_waitcnt lgkmcnt(0)
    s_mov_b32 s36, s8
    s_mov_b32 s37, s9
    s_mov_b32 s38, 7168
    s_mov_b32 s39, 0x20000
    s_mul_i32 s48, s35, 1792
    s_load_dwordx2 s[92:93], s[32:33], 458752
    buffer_load_dwordx4 v[16:19], v4, s[36:39], s48 offen
    buffer_load_dwordx4 v[20:23], v4, s[36:39], s48 offen offset:896
    s_cmp_lg_u32 s35, 0
    s_cbranch_scc1 L_sv_nowq
    s_mov_b32 s40, s14
    s_mov_b32 s41, s15
    s_mov_b32 s42, 3670016
    s_mov_b32 s43, 0x20000
    s_and_b32 s54, s2, 7
    s_mov_b32 s49, 20
    s_lshr_b32 s48, s2, 3
    s_add_u32 s49, s49, s48
    s_and_b32 s49, s49, 31
    s_lshl_b32 s54, s54, 5
    s_add_u32 s54, s54, s49
    v_lshrrev_b32 v6, 3, v2
    v_mul_u32_u24 v6, 224, v6
    v_lshl_add_u32 v6, v3, 3, v6
    v_lshlrev_b32 v6, 13, v6
    v_and_b32 v7, 7, v2
    v_lshl_add_u32 v6, v7, 2, v6
    s_lshl_b32 s48, s54, 5
    s_add_u32 s49, s48, 0
    buffer_load_dword v64, v6, s[40:43], s49 offen sc0
    s_add_u32 s49, s48, 8192
    buffer_load_dword v65, v6, s[40:43], s49 offen sc0
    s_add_u32 s49, s48, 16384
    buffer_load_dword v66, v6, s[40:43], s49 offen sc0
    s_add_u32 s49, s48, 24576
    buffer_load_dword v67, v6, s[40:43], s49 offen sc0
    s_add_u32 s49, s48, 32768
    buffer_load_dword v68, v6, s[40:43], s49 offen sc0
    s_add_u32 s49, s48, 40960
    buffer_load_dword v69, v6, s[40:43], s49 offen sc0
    s_add_u32 s49, s48, 49152
    buffer_load_dword v70, v6, s[40:43], s49 offen sc0
    s_add_u32 s49, s48, 57344
    buffer_load_dword v71, v6, s[40:43], s49 offen sc0
    s_add_u32 s49, s48, 262144
    buffer_load_dword v72, v6, s[40:43], s49 offen sc0
    s_add_u32 s49, s48, 270336
    buffer_load_dword v73, v6, s[40:43], s49 offen sc0
    s_add_u32 s49, s48, 278528
    buffer_load_dword v74, v6, s[40:43], s49 offen sc0
    s_add_u32 s49, s48, 286720
    buffer_load_dword v75, v6, s[40:43], s49 offen sc0
    s_add_u32 s49, s48, 294912
    buffer_load_dword v76, v6, s[40:43], s49 offen sc0
    s_add_u32 s49, s48, 303104
    buffer_load_dword v77, v6, s[40:43], s49 offen sc0
    s_add_u32 s49, s48, 311296
    buffer_load_dword v78, v6, s[40:43], s49 offen sc0
    s_add_u32 s49, s48, 319488
    buffer_load_dword v79, v6, s[40:43], s49 offen sc0
    s_add_u32 s49, s48, 524288
    buffer_load_dword v80, v6, s[40:43], s49 offen sc0
    s_add_u32 s49, s48, 532480
    buffer_load_dword v81, v6, s[40:43], s49 offen sc0
    s_add_u32 s49, s48, 540672
    buffer_load_dword v82, v6, s[40:43], s49 offen sc0
    s_add_u32 s49, s48, 548864
    buffer_load_dword v83, v6, s[40:43], s49 offen sc0
    s_add_u32 s49, s48, 557056
    buffer_load_dword v84, v6, s[40:43], s49 offen sc0
    s_add_u32 s49, s48, 565248
    buffer_load_dword v85, v6, s[40:43], s49 offen sc0
    s_add_u32 s49, s48, 573440
    buffer_load_dword v86, v6, s[40:43], s49 offen sc0
    s_add_u32 s49, s48, 581632
    buffer_load_dword v87, v6, s[40:43], s49 offen sc0
    s_add_u32 s49, s48, 786432
    buffer_load_dword v88, v6, s[40:43], s49 offen sc0
    s_add_u32 s49, s48, 794624
    buffer_load_dword v89, v6, s[40:43], s49 offen sc0
    s_add_u32 s49, s48, 802816
    buffer_load_dword v90, v6, s[40:43], s49 offen sc0
    s_add_u32 s49, s48, 811008
    buffer_load_dword v91, v6, s[40:43], s49 offen sc0
    s_add_u32 s49, s48, 819200
    buffer_load_dword v92, v6, s[40:43], s49 offen sc0
    s_add_u32 s49, s48, 827392
    buffer_load_dword v93, v6, s[40:43], s49 offen sc0
    s_add_u32 s49, s48, 835584
    buffer_load_dword v94, v6, s[40:43], s49 offen sc0
    s_add_u32 s49, s48, 843776
    buffer_load_dword v95, v6, s[40:43], s49 offen sc0
    s_add_u32 s49, s48, 1048576
    buffer_load_dword v96, v6, s[40:43], s49 offen sc0
    s_add_u32 s49, s48, 1056768
    buffer_load_dword v97, v6, s[40:43], s49 offen sc0
    s_add_u32 s49, s48, 1064960
    buffer_load_dword v98, v6, s[40:43], s49 offen sc0
    s_add_u32 s49, s48, 1073152
    buffer_load_dword v99, v6, s[40:43], s49 offen sc0
    s_add_u32 s49, s48, 1081344
    buffer_load_dword v100, v6, s[40:43], s49 offen sc0
    s_add_u32 s49, s48, 1089536
    buffer_load_dword v101, v6, s[40:43], s49 offen sc0
    s_add_u32 s49, s48, 1097728
    buffer_load_dword v102, v6, s[40:43], s49 offen sc0
    s_add_u32 s49, s48, 1105920
    buffer_load_dword v103, v6, s[40:43], s49 offen sc0
    s_add_u32 s49, s48, 1310720
    buffer_load_dword v104, v6, s[40:43], s49 offen sc0
    s_add_u32 s49, s48, 1318912
    buffer_load_dword v105, v6, s[40:43], s49 offen sc0
    s_add_u32 s49, s48, 1327104
    buffer_load_dword v106, v6, s[40:43], s49 offen sc0
    s_add_u32 s49, s48, 1335296
    buffer_load_dword v107, v6, s[40:43], s49 offen sc0
    s_add_u32 s49, s48, 1343488
    buffer_load_dword v108, v6, s[40:43], s49 offen sc0
    s_add_u32 s49, s48, 1351680
    buffer_load_dword v109, v6, s[40:43], s49 offen sc0
    s_add_u32 s49, s48, 1359872
    buffer_load_dword v110, v6, s[40:43], s49 offen sc0
    s_add_u32 s49, s48, 1368064
    buffer_load_dword v111, v6, s[40:43], s49 offen sc0
    s_add_u32 s49, s48, 1572864
    buffer_load_dword v112, v6, s[40:43], s49 offen sc0
    s_add_u32 s49, s48, 1581056
    buffer_load_dword v113, v6, s[40:43], s49 offen sc0
    s_add_u32 s49, s48, 1589248
    buffer_load_dword v114, v6, s[40:43], s49 offen sc0
    s_add_u32 s49, s48, 1597440
    buffer_load_dword v115, v6, s[40:43], s49 offen sc0
    s_add_u32 s49, s48, 1605632
    buffer_load_dword v116, v6, s[40:43], s49 offen sc0
    s_add_u32 s49, s48, 1613824
    buffer_load_dword v117, v6, s[40:43], s49 offen sc0
    s_add_u32 s49, s48, 1622016
    buffer_load_dword v118, v6, s[40:43], s49 offen sc0
    s_add_u32 s49, s48, 1630208
    buffer_load_dword v119, v6, s[40:43], s49 offen sc0
    ds_write_b128 v5, v[8:11]
    ds_write_b128 v5, v[8:11] offset:16
    ds_write_b128 v4, v[8:11] offset:35840
L_sv_nowq:
    s_cmp_lg_u32 s35, 1
    s_cbranch_scc1 L_sv_noclr
    v_mov_b32 v12, -1
    v_mov_b32 v13, -1
    v_mov_b32 v14, -1
    v_mov_b32 v15, -1
    s_lshl_b32 s48, s7, 13
    s_lshl_b32 s49, s6, 11
    s_add_u32 s48, s48, s49
    s_add_u32 s48, s48, 589824
    s_add_u32 s48, s48, s98
    s_add_u32 s44, s32, s48
    s_addc_u32 s45, s33, 0
    s_mov_b32 s46, 2048
    s_mov_b32 s47, 0x20000
    buffer_store_dwordx4 v[12:15], v4, s[44:47], 0 offen sc1
    buffer_store_dwordx4 v[12:15], v4, s[44:47], 0 offen offset:1024 sc1
    s_lshl_b32 s48, s7, 7
    s_lshl_b32 s49, s6, 4
    s_add_u32 s48, s48, s49
    s_add_u32 s48, s48, 524288
    s_add_u32 s48, s48, s98
    s_add_u32 s44, s32, s48
    s_addc_u32 s45, s33, 0
    s_mov_b32 s46, 16
    s_mov_b32 s47, 0x20000
    buffer_store_dwordx4 v[12:15], v4, s[44:47], 0 offen sc1
    s_mul_i32 s48, s7, 1792
    s_lshl_b32 s49, s6, 9
    s_add_u32 s48, s48, s49
    s_add_u32 s48, s48, 1114112
    s_add_u32 s48, s48, s98
    s_add_u32 s44, s32, s48
    s_addc_u32 s45, s33, 0
    s_mov_b32 s46, 512
    s_mov_b32 s47, 0x20000
    s_cmp_eq_u32 s6, 3
    s_cselect_b32 s46, 256, s46
    buffer_store_dwordx4 v[12:15], v4, s[44:47], 0 offen sc1
    s_max_i32 s49, s34, 0
    s_lshl_b32 s48, s4, 5
    s_add_u32 s48, s48, s49
    s_mul_i32 s48, s48, 1792
    s_add_u32 s48, s48, 1245184
    s_add_u32 s48, s48, s98
    s_add_u32 s44, s32, s48
    s_addc_u32 s45, s33, 0
    s_mov_b32 s46, 1792
    s_mov_b32 s47, 0x20000
    s_cmp_lt_i32 s34, 0
    s_cselect_b32 s46, 0, s46
    buffer_store_dwordx4 v[12:15], v4, s[44:47], 0 offen sc1
    buffer_store_dwordx4 v[12:15], v4, s[44:47], 0 offen offset:1024 sc1
L_sv_noclr:
    s_lshl_b32 s48, s35, 10
    v_add_u32 v6, s48, v4
    ds_write_b128 v6, v[8:11] offset:20480
    s_waitcnt lgkmcnt(0)
    s_barrier
    s_add_u32 s93, s93, 1
    s_cmp_lg_u32 s35, 0
    s_cbranch_scc1 L_sv_w0
    s_waitcnt vmcnt(56)
    s_branch L_sv_w1
L_sv_w0:
    s_waitcnt vmcnt(6)
    s_cmp_eq_u32 s35, 1
    s_cbranch_scc1 L_sv_w1
    s_waitcnt vmcnt(0)
L_sv_w1:
    v_lshlrev_b32 v24, 16, v16
    v_and_b32 v25, 0xffff0000, v16
    v_lshlrev_b32 v26, 16, v17
    v_and_b32 v27, 0xffff0000, v17
    v_lshlrev_b32 v28, 16, v18
    v_and_b32 v29, 0xffff0000, v18
    v_lshlrev_b32 v30, 16, v19
    v_and_b32 v31, 0xffff0000, v19
    v_lshlrev_b32 v32, 16, v20
    v_and_b32 v33, 0xffff0000, v20
    v_lshlrev_b32 v34, 16, v21
    v_and_b32 v35, 0xffff0000, v21
    v_lshlrev_b32 v36, 16, v22
    v_and_b32 v37, 0xffff0000, v22
    v_lshlrev_b32 v38, 16, v23
    v_and_b32 v39, 0xffff0000, v23
    v_add_f32 v40, v24, v25
    v_add_f32 v40, v40, v26
    v_add_f32 v40, v40, v27
    v_add_f32 v40, v40, v28
    v_add_f32 v40, v40, v29
    v_add_f32 v40, v40, v30
    v_add_f32 v40, v40, v31
    v_cndmask_b32 v40, 0, v40, s[52:53]
    v_add_f32 v41, v32, v33
    v_add_f32 v41, v41, v34
    v_add_f32 v41, v41, v35
    v_add_f32 v41, v41, v36
    v_add_f32 v41, v41, v37
    v_add_f32 v41, v41, v38
    v_add_f32 v41, v41, v39
    v_cndmask_b32 v41, 0, v41, s[52:53]
    s_nop 1
    v_add_f32_dpp v40, v40, v40 quad_perm:[1,0,3,2] row_mask:0xf bank_mask:0xf
    v_add_f32_dpp v41, v41, v41 quad_perm:[1,0,3,2] row_mask:0xf bank_mask:0xf
    s_nop 1
    v_add_f32_dpp v40, v40, v40 quad_perm:[2,3,0,1] row_mask:0xf bank_mask:0xf
    v_add_f32_dpp v41, v41, v41 quad_perm:[2,3,0,1] row_mask:0xf bank_mask:0xf
    s_nop 1
    v_add_f32_dpp v40, v40, v40 row_half_mirror row_mask:0xf bank_mask:0xf
    v_add_f32_dpp v41, v41, v41 row_half_mirror row_mask:0xf bank_mask:0xf
    s_nop 1
    v_add_f32_dpp v40, v40, v40 row_mirror row_mask:0xf bank_mask:0xf
    v_add_f32_dpp v41, v41, v41 row_mirror row_mask:0xf bank_mask:0xf
    v_mov_b32 v42, v40
    v_mov_b32 v43, v41
    s_nop 1
    v_permlane16_swap_b32 v40, v42
    v_permlane16_swap_b32 v41, v43
    s_nop 1
    v_add_f32 v40, v40, v42
    v_add_f32 v41, v41, v43
    v_mov_b32 v42, v40
    v_mov_b32 v43, v41
    s_nop 1
    v_permlane32_swap_b32 v40, v42
    v_permlane32_swap_b32 v41, v43
    s_nop 1
    v_add_f32 v40, v40, v42
    v_add_f32 v41, v41, v43
    v_mul_f32 v44, 0x3b124925, v40
    v_mul_f32 v45, 0x3b124925, v41
    v_sub_f32 v46, v24, v44
    v_sub_f32 v47, v25, v44
    v_sub_f32 v48, v26, v44
    v_sub_f32 v49, v27, v44
    v_sub_f32 v50, v28, v44
    v_sub_f32 v51, v29, v44
    v_sub_f32 v52, v30, v44
    v_sub_f32 v53, v31, v44
    v_mul_f32 v40, v46, v46
    v_fmac_f32 v40, v47, v47
    v_fmac_f32 v40, v48, v48
    v_fmac_f32 v40, v49, v49
    v_fmac_f32 v40, v50, v50
    v_fmac_f32 v40, v51, v51
    v_fmac_f32 v40, v52, v52
    v_fmac_f32 v40, v53, v53
    v_cndmask_b32 v40, 0, v40, s[52:53]
    v_sub_f32 v46, v32, v45
    v_sub_f32 v47, v33, v45
    v_sub_f32 v48, v34, v45
    v_sub_f32 v49, v35, v45
    v_sub_f32 v50, v36, v45
    v_sub_f32 v51, v37, v45
    v_sub_f32 v52, v38, v45
    v_sub_f32 v53, v39, v45
    v_mul_f32 v41, v46, v46
    v_fmac_f32 v41, v47, v47
    v_fmac_f32 v41, v48, v48
    v_fmac_f32 v41, v49, v49
    v_fmac_f32 v41, v50, v50
    v_fmac_f32 v41, v51, v51
    v_fmac_f32 v41, v52, v52
    v_fmac_f32 v41, v53, v53
    v_cndmask_b32 v41, 0, v41, s[52:53]
    s_nop 1
    v_add_f32_dpp v40, v40, v40 quad_perm:[1,0,3,2] row_mask:0xf bank_mask:0xf
    v_add_f32_dpp v41, v41, v41 quad_perm:[1,0,3,2] row_mask:0xf bank_mask:0xf
    s_nop 1
    v_add_f32_dpp v40, v40, v40 quad_perm:[2,3,0,1] row_mask:0xf bank_mask:0xf
    v_add_f32_dpp v41, v41, v41 quad_perm:[2,3,0,1] row_mask:0xf bank_mask:0xf
    s_nop 1
    v_add_f32_dpp v40, v40, v40 row_half_mirror row_mask:0xf bank_mask:0xf
    v_add_f32_dpp v41, v41, v41 row_half_mirror row_mask:0xf bank_mask:0xf
    s_nop 1
    v_add_f32_dpp v40, v40, v40 row_mirror row_mask:0xf bank_mask:0xf
    v_add_f32_dpp v41, v41, v41 row_mirror row_mask:0xf bank_mask:0xf
    v_mov_b32 v42, v40
    v_mov_b32 v43, v41
    s_nop 1
    v_permlane16_swap_b32 v40, v42
    v_permlane16_swap_b32 v41, v43
    s_nop 1
    v_add_f32 v40, v40, v42
    v_add_f32 v41, v41, v43
    v_mov_b32 v42, v40
    v_mov_b32 v43, v41
    s_nop 1
    v_permlane32_swap_b32 v40, v42
    v_permlane32_swap_b32 v41, v43
    s_nop 1
    v_add_f32 v40, v40, v42
    v_add_f32 v41, v41, v43
    v_mul_f32 v40, 0x3b124925, v40
    v_cvt_pk_bf16_f32 v42, v44, v40
    v_lshlrev_b32 v44, 16, v42
    v_and_b32 v40, 0xffff0000, v42
    v_add_f32 v40, 0x3727c5ac, v40
    v_cvt_pk_bf16_f32 v40, v40, v40
    v_lshlrev_b32 v40, 16, v40
    v_sqrt_f32 v40, v40
    s_nop 0
    v_cvt_pk_bf16_f32 v40, v40, v40
    v_lshlrev_b32 v40, 16, v40
    v_rcp_f32 v40, v40
    v_sub_f32 v46, v24, v44
    v_sub_f32 v47, v25, v44
    v_sub_f32 v48, v26, v44
    v_sub_f32 v49, v27, v44
    v_sub_f32 v50, v28, v44
    v_sub_f32 v51, v29, v44
    v_sub_f32 v52, v30, v44
    v_sub_f32 v53, v31, v44
    v_cvt_pk_bf16_f32 v16, v46, v47
    v_cvt_pk_bf16_f32 v17, v48, v49
    v_cvt_pk_bf16_f32 v18, v50, v51
    v_cvt_pk_bf16_f32 v19, v52, v53
    v_lshlrev_b32 v46, 16, v16
    v_and_b32 v47, 0xffff0000, v16
    v_lshlrev_b32 v48, 16, v17
    v_and_b32 v49, 0xffff0000, v17
    v_lshlrev_b32 v50, 16, v18
    v_and_b32 v51, 0xffff0000, v18
    v_lshlrev_b32 v52, 16, v19
    v_and_b32 v53, 0xffff0000, v19
    v_mul_f32 v46, v46, v40
    v_mul_f32 v47, v47, v40
    v_mul_f32 v48, v48, v40
    v_mul_f32 v49, v49, v40
    v_mul_f32 v50, v50, v40
    v_mul_f32 v51, v51, v40
    v_mul_f32 v52, v52, v40
    v_mul_f32 v53, v53, v40
    v_cvt_pk_bf16_f32 v16, v46, v47
    v_cvt_pk_bf16_f32 v17, v48, v49
    v_cvt_pk_bf16_f32 v18, v50, v51
    v_cvt_pk_bf16_f32 v19, v52, v53
    v_mul_f32 v41, 0x3b124925, v41
    v_cvt_pk_bf16_f32 v43, v45, v41
    v_lshlrev_b32 v45, 16, v43
    v_and_b32 v41, 0xffff0000, v43
    v_add_f32 v41, 0x3727c5ac, v41
    v_cvt_pk_bf16_f32 v41, v41, v41
    v_lshlrev_b32 v41, 16, v41
    v_sqrt_f32 v41, v41
    s_nop 0
    v_cvt_pk_bf16_f32 v41, v41, v41
    v_lshlrev_b32 v41, 16, v41
    v_rcp_f32 v41, v41
    v_sub_f32 v46, v32, v45
    v_sub_f32 v47, v33, v45
    v_sub_f32 v48, v34, v45
    v_sub_f32 v49, v35, v45
    v_sub_f32 v50, v36, v45
    v_sub_f32 v51, v37, v45
    v_sub_f32 v52, v38, v45
    v_sub_f32 v53, v39, v45
    v_cvt_pk_bf16_f32 v20, v46, v47
    v_cvt_pk_bf16_f32 v21, v48, v49
    v_cvt_pk_bf16_f32 v22, v50, v51
    v_cvt_pk_bf16_f32 v23, v52, v53
    v_lshlrev_b32 v46, 16, v20
    v_and_b32 v47, 0xffff0000, v20
    v_lshlrev_b32 v48, 16, v21
    v_and_b32 v49, 0xffff0000, v21
    v_lshlrev_b32 v50, 16, v22
    v_and_b32 v51, 0xffff0000, v22
    v_lshlrev_b32 v52, 16, v23
    v_and_b32 v53, 0xffff0000, v23
    v_mul_f32 v46, v46, v41
    v_mul_f32 v47, v47, v41
    v_mul_f32 v48, v48, v41
    v_mul_f32 v49, v49, v41
    v_mul_f32 v50, v50, v41
    v_mul_f32 v51, v51, v41
    v_mul_f32 v52, v52, v41
    v_mul_f32 v53, v53, v41
    v_cvt_pk_bf16_f32 v20, v46, v47
    v_cvt_pk_bf16_f32 v21, v48, v49
    v_cvt_pk_bf16_f32 v22, v50, v51
    v_cvt_pk_bf16_f32 v23, v52, v53
    s_mul_i32 s48, s35, 1792
    v_add_u32 v6, s48, v4
    s_mov_b64 exec, s[52:53]
    ds_write_b128 v6, v[16:19] offset:0
    ds_write_b128 v6, v[20:23] offset:896
    v_mov_b32 v7, 1
    s_waitcnt lgkmcnt(0)
    s_mov_b64 exec, 1
    ds_add_u32 v5, v7
    s_mov_b64 exec, -1
    s_cmp_eq_u32 s35, 0
    s_cbranch_scc1 L_sv_q
    s_cmp_lg_u32 s35, 1
    s_cbranch_scc1 L_sv_weights
    s_lshl_b32 s48, s4, 5
    s_add_u32 s48, s48, s34
    s_add_u32 s48, s48, 4
    s_lshl_b32 s48, s48, 3
    s_add_u32 s48, s48, 462848
    v_mov_b32 v6, s48
    v_mov_b32 v12, s92
    v_mov_b32 v13, s93
    s_waitcnt vmcnt(0)
    s_mov_b64 exec, 1
    global_store_dwordx2 v6, v[12:13], s[32:33] sc1
    s_mov_b64 exec, -1
    s_branch L_sv_weights
L_sv_q:
    v_mov_b32 v62, s92
    v_mov_b32 v63, s93
    s_mov_b32 s55, 0x05040302
    v_and_b32 v6, 7, v2
    v_mul_u32_u24 v6, 896, v6
    v_lshl_add_u32 v6, v3, 4, v6
    v_lshrrev_b32 v7, 3, v2
    v_mul_u32_u24 v7, 448, v7
    v_add_u32 v6, v6, v7
    s_waitcnt vmcnt(48)
    v_perm_b32 v128, v65, v64, s56
    v_perm_b32 v129, v67, v66, s56
    v_perm_b32 v130, v69, v68, s56
    v_perm_b32 v131, v71, v70, s56
    v_perm_b32 v132, v65, v64, s57
    v_perm_b32 v133, v67, v66, s57
    v_perm_b32 v134, v69, v68, s57
    v_perm_b32 v135, v71, v70, s57
    s_waitcnt vmcnt(40)
    v_perm_b32 v136, v73, v72, s56
    v_perm_b32 v137, v75, v74, s56
    v_perm_b32 v138, v77, v76, s56
    v_perm_b32 v139, v79, v78, s56
    v_perm_b32 v140, v73, v72, s57
    v_perm_b32 v141, v75, v74, s57
    v_perm_b32 v142, v77, v76, s57
    v_perm_b32 v143, v79, v78, s57
    s_waitcnt vmcnt(32)
    v_perm_b32 v144, v81, v80, s56
    v_perm_b32 v145, v83, v82, s56
    v_perm_b32 v146, v85, v84, s56
    v_perm_b32 v147, v87, v86, s56
    v_perm_b32 v148, v81, v80, s57
    v_perm_b32 v149, v83, v82, s57
    v_perm_b32 v150, v85, v84, s57
    v_perm_b32 v151, v87, v86, s57
    s_waitcnt vmcnt(24)
    v_perm_b32 v152, v89, v88, s56
    v_perm_b32 v153, v91, v90, s56
    v_perm_b32 v154, v93, v92, s56
    v_perm_b32 v155, v95, v94, s56
    v_perm_b32 v156, v89, v88, s57
    v_perm_b32 v157, v91, v90, s57
    v_perm_b32 v158, v93, v92, s57
    v_perm_b32 v159, v95, v94, s57
    s_waitcnt vmcnt(16)
    v_perm_b32 v160, v97, v96, s56
    v_perm_b32 v161, v99, v98, s56
    v_perm_b32 v162, v101, v100, s56
    v_perm_b32 v163, v103, v102, s56
    v_perm_b32 v164, v97, v96, s57
    v_perm_b32 v165, v99, v98, s57
    v_perm_b32 v166, v101, v100, s57
    v_perm_b32 v167, v103, v102, s57
    s_waitcnt vmcnt(8)
    v_perm_b32 v168, v105, v104, s56
    v_perm_b32 v169, v107, v106, s56
    v_perm_b32 v170, v109, v108, s56
    v_perm_b32 v171, v111, v110, s56
    v_perm_b32 v172, v105, v104, s57
    v_perm_b32 v173, v107, v106, s57
    v_perm_b32 v174, v109, v108, s57
    v_perm_b32 v175, v111, v110, s57
    s_waitcnt vmcnt(0)
    v_perm_b32 v176, v113, v112, s56
    v_perm_b32 v177, v115, v114, s56
    v_perm_b32 v178, v117, v116, s56
    v_perm_b32 v179, v119, v118, s56
    v_perm_b32 v180, v113, v112, s57
    v_perm_b32 v181, v115, v114, s57
    v_perm_b32 v182, v117, v116, s57
    v_perm_b32 v183, v119, v118, s57
    s_mov_b32 s59, 800000
L_spin_5:
    ds_read_b32 v12, v5 offset:0
    s_waitcnt lgkmcnt(0)
    v_readfirstlane_b32 s50, v12
    s_nop 0
    s_cmp_eq_u32 s50, 4
    s_cbranch_scc1 L_spun_6
    s_sleep 1
    s_sub_u32 s59, s59, 1
    s_cmp_lg_u32 s59, 0
    s_cbranch_scc1 L_spin_5
L_spun_6:
    ds_read_b128 v[16:19], v6 offset:0
    ds_read_b128 v[20:23], v6 offset:64
    ds_read_b128 v[24:27], v6 offset:128
    ds_read_b128 v[28:31], v6 offset:192
    ds_read_b128 v[32:35], v6 offset:256
    ds_read_b128 v[36:39], v6 offset:320
    ds_read_b128 v[40:43], v6 offset:384
    s_mov_b32 s48, 0
    s_add_u32 s44, s32, s48
    s_addc_u32 s45, s33, 0
    s_mov_b32 s46, 262144
    s_mov_b32 s47, 0x20000
    s_mov_b32 s49, 131072
    v_mul_lo_u32 v6, s49, v3
    v_lshl_add_u32 v6, v2, 4, v6
    s_lshl_b32 s48, s54, 7
    s_waitcnt lgkmcnt(6)
    v_mfma_f32_16x16x32_bf16 v[48:51], v[16:19], v[128:131], 0
    v_mfma_f32_16x16x32_bf16 v[52:55], v[16:19], v[132:135], 0
    s_waitcnt lgkmcnt(5)
    v_mfma_f32_16x16x32_bf16 v[48:51], v[20:23], v[136:139], v[48:51]
    v_mfma_f32_16x16x32_bf16 v[52:55], v[20:23], v[140:143], v[52:55]
    s_waitcnt lgkmcnt(4)
    v_mfma_f32_16x16x32_bf16 v[48:51], v[24:27], v[144:147], v[48:51]
    v_mfma_f32_16x16x32_bf16 v[52:55], v[24:27], v[148:151], v[52:55]
    s_waitcnt lgkmcnt(3)
    v_mfma_f32_16x16x32_bf16 v[48:51], v[28:31], v[152:155], v[48:51]
    v_mfma_f32_16x16x32_bf16 v[52:55], v[28:31], v[156:159], v[52:55]
    s_waitcnt lgkmcnt(2)
    v_mfma_f32_16x16x32_bf16 v[48:51], v[32:35], v[160:163], v[48:51]
    v_mfma_f32_16x16x32_bf16 v[52:55], v[32:35], v[164:167], v[52:55]
    s_waitcnt lgkmcnt(1)
    v_mfma_f32_16x16x32_bf16 v[48:51], v[36:39], v[168:171], v[48:51]
    v_mfma_f32_16x16x32_bf16 v[52:55], v[36:39], v[172:175], v[52:55]
    s_waitcnt lgkmcnt(0)
    v_mfma_f32_16x16x32_bf16 v[48:51], v[40:43], v[176:179], v[48:51]
    v_mfma_f32_16x16x32_bf16 v[52:55], v[40:43], v[180:183], v[52:55]
    s_nop 7
    s_nop 1
    v_mov_b32_dpp v16, v48 row_ror:8 row_mask:0xf bank_mask:0xf
    v_mov_b32_dpp v17, v49 row_ror:8 row_mask:0xf bank_mask:0xf
    v_mov_b32_dpp v18, v50 row_ror:8 row_mask:0xf bank_mask:0xf
    v_mov_b32_dpp v19, v51 row_ror:8 row_mask:0xf bank_mask:0xf
    v_mov_b32_dpp v20, v52 row_ror:8 row_mask:0xf bank_mask:0xf
    v_mov_b32_dpp v21, v53 row_ror:8 row_mask:0xf bank_mask:0xf
    v_mov_b32_dpp v22, v54 row_ror:8 row_mask:0xf bank_mask:0xf
    v_mov_b32_dpp v23, v55 row_ror:8 row_mask:0xf bank_mask:0xf
    s_nop 1
    v_permlane32_swap_b32 v16, v24
    v_permlane32_swap_b32 v17, v25
    v_permlane32_swap_b32 v18, v26
    v_permlane32_swap_b32 v19, v27
    v_permlane32_swap_b32 v20, v28
    v_permlane32_swap_b32 v21, v29
    v_permlane32_swap_b32 v22, v30
    v_permlane32_swap_b32 v23, v31
    s_nop 1
    v_add_f32 v48, v48, v24
    v_add_f32 v49, v49, v25
    v_add_f32 v50, v50, v26
    v_add_f32 v51, v51, v27
    v_add_f32 v52, v52, v28
    v_add_f32 v53, v53, v29
    v_add_f32 v54, v54, v30
    v_add_f32 v55, v55, v31
    v_cvt_pk_bf16_f32 v16, v48, v52
    v_perm_b32 v32, v62, v16, s56
    v_mov_b32 v33, v63
    v_perm_b32 v34, v62, v16, s55
    v_mov_b32 v35, v63
    v_cvt_pk_bf16_f32 v17, v49, v53
    v_perm_b32 v36, v62, v17, s56
    v_mov_b32 v37, v63
    v_perm_b32 v38, v62, v17, s55
    v_mov_b32 v39, v63
    v_cvt_pk_bf16_f32 v18, v50, v54
    v_perm_b32 v40, v62, v18, s56
    v_mov_b32 v41, v63
    v_perm_b32 v42, v62, v18, s55
    v_mov_b32 v43, v63
    v_cvt_pk_bf16_f32 v19, v51, v55
    v_perm_b32 v44, v62, v19, s56
    v_mov_b32 v45, v63
    v_perm_b32 v46, v62, v19, s55
    v_mov_b32 v47, v63
    s_mov_b64 exec, 0x00ff00ff
    s_add_u32 s49, s48, 0
    buffer_store_dwordx4 v[32:35], v6, s[44:47], s49 offen sc1
    s_add_u32 s49, s48, 32768
    buffer_store_dwordx4 v[36:39], v6, s[44:47], s49 offen sc1
    s_add_u32 s49, s48, 65536
    buffer_store_dwordx4 v[40:43], v6, s[44:47], s49 offen sc1
    s_add_u32 s49, s48, 98304
    buffer_store_dwordx4 v[44:47], v6, s[44:47], s49 offen sc1
    s_mov_b64 exec, -1
    v_lshlrev_b32 v6, 6, v0
    s_lshl_b32 s48, s4, 15
    s_lshl_b32 s49, s5, 12
    s_add_u32 s48, s48, s49
    s_add_u32 s48, s48, s98
    v_lshlrev_b32 v61, 16, v62
    s_mov_b32 s59, 800000
L_spin_7:
    ds_read_b32 v12, v5 offset:16
    s_waitcnt lgkmcnt(0)
    v_readfirstlane_b32 s50, v12
    s_nop 0
    s_cmp_eq_u32 s50, 1
    s_cbranch_scc1 L_spun_8
    s_sleep 1
    s_sub_u32 s59, s59, 1
    s_cmp_lg_u32 s59, 0
    s_cbranch_scc1 L_spin_7
L_spun_8:
    s_mov_b32 s51, 40000
L_sv_qpoll:
    buffer_load_dwordx4 v[16:19], v6, s[44:47], s48 offen offset:0 sc1
    buffer_load_dwordx4 v[20:23], v6, s[44:47], s48 offen offset:16 sc1
    buffer_load_dwordx4 v[24:27], v6, s[44:47], s48 offen offset:32 sc1
    buffer_load_dwordx4 v[28:31], v6, s[44:47], s48 offen offset:48 sc1
    s_waitcnt vmcnt(0)
    v_xor_b32 v48, v61, v16
    v_xor_b32 v49, v61, v18
    v_xor_b32 v50, v61, v20
    v_xor_b32 v51, v61, v22
    v_xor_b32 v52, v61, v24
    v_xor_b32 v53, v61, v26
    v_xor_b32 v54, v61, v28
    v_xor_b32 v55, v61, v30
    v_or3_b32 v12, v48, v49, v50
    v_or3_b32 v12, v12, v51, v52
    v_or3_b32 v12, v12, v53, v54
    v_or_b32 v12, v12, v55
    v_lshrrev_b32 v12, 16, v12
    v_xor_b32 v48, v63, v17
    v_xor_b32 v49, v63, v19
    v_xor_b32 v50, v63, v21
    v_xor_b32 v51, v63, v23
    v_xor_b32 v52, v63, v25
    v_xor_b32 v53, v63, v27
    v_xor_b32 v54, v63, v29
    v_xor_b32 v55, v63, v31
    v_or3_b32 v12, v12, v48, v49
    v_or3_b32 v12, v12, v50, v51
    v_or3_b32 v12, v12, v52, v53
    v_or3_b32 v12, v12, v54, v55
    v_cmp_ne_u32 vcc, 0, v12
    s_cbranch_vccz L_sv_qok
    s_sleep 8
    s_sub_u32 s51, s51, 1
    s_cmp_lg_u32 s51, 0
    s_cbranch_scc1 L_sv_qpoll
L_sv_qok:
    v_perm_b32 v48, v18, v16, s56
    v_perm_b32 v49, v22, v20, s56
    v_perm_b32 v50, v26, v24, s56
    v_perm_b32 v51, v30, v28, s56
L_sv_qskip:
    ds_write_b128 v4, v[48:51] offset:7168
    v_mov_b32 v7, 1
    s_waitcnt lgkmcnt(0)
    ds_write_b32 v5, v7 offset:4
L_sv_weights:
    s_mov_b32 s59, 800000
L_spin_9:
    ds_read_b32 v12, v5 offset:4
    s_waitcnt lgkmcnt(0)
    v_readfirstlane_b32 s50, v12
    s_nop 0
    s_cmp_eq_u32 s50, 1
    s_cbranch_scc1 L_spun_10
    s_sleep 1
    s_sub_u32 s59, s59, 1
    s_cmp_lg_u32 s59, 0
    s_cbranch_scc1 L_spin_9
L_spun_10:
    s_mov_b32 s40, s16
    s_mov_b32 s41, s17
    s_mov_b32 s42, 3670016
    s_mov_b32 s43, 0x20000
    v_mul_u32_u24 v6, 7168, v3
    v_lshl_add_u32 v6, v2, 4, v6
    s_lshl_b32 s48, s5, 9
    s_lshl_b32 s49, s35, 7
    s_add_u32 s48, s48, s49
    s_mul_i32 s48, s48, 896
    s_lshl_b32 s49, s6, 8
    s_add_u32 s48, s48, s49
    s_cmp_eq_u32 s6, 3
    s_cselect_b32 s50, 0x00ff00ff, -1
    s_mov_b32 s51, s50
    s_mov_b64 exec, s[50:51]
    s_add_u32 s49, s48, 0
    buffer_load_dwordx4 v[16:19], v6, s[40:43], s49 offen offset:0
    buffer_load_dwordx4 v[20:23], v6, s[40:43], s49 offen offset:896
    buffer_load_dwordx4 v[24:27], v6, s[40:43], s49 offen offset:1792
    buffer_load_dwordx4 v[28:31], v6, s[40:43], s49 offen offset:2688
    s_add_u32 s49, s48, 3584
    s_waitcnt vmcnt(3)
    buffer_load_dwordx4 v[32:35], v6, s[40:43], s49 offen offset:0
    s_waitcnt vmcnt(3)
    buffer_load_dwordx4 v[36:39], v6, s[40:43], s49 offen offset:896
    s_waitcnt vmcnt(3)
    buffer_load_dwordx4 v[40:43], v6, s[40:43], s49 offen offset:1792
    s_waitcnt vmcnt(3)
    buffer_load_dwordx4 v[44:47], v6, s[40:43], s49 offen offset:2688
    s_mov_b64 exec, -1
    s_waitcnt vmcnt(0)
    v_perm_b32 v64, v20, v16, s56
    v_perm_b32 v65, v28, v24, s56
    v_perm_b32 v66, v36, v32, s56
    v_perm_b32 v67, v44, v40, s56
    v_perm_b32 v68, v20, v16, s57
    v_perm_b32 v69, v28, v24, s57
    v_perm_b32 v70, v36, v32, s57
    v_perm_b32 v71, v44, v40, s57
    v_perm_b32 v72, v21, v17, s56
    v_perm_b32 v73, v29, v25, s56
    v_perm_b32 v74, v37, v33, s56
    v_perm_b32 v75, v45, v41, s56
    v_perm_b32 v76, v21, v17, s57
    v_perm_b32 v77, v29, v25, s57
    v_perm_b32 v78, v37, v33, s57
    v_perm_b32 v79, v45, v41, s57
    v_perm_b32 v80, v22, v18, s56
    v_perm_b32 v81, v30, v26, s56
    v_perm_b32 v82, v38, v34, s56
    v_perm_b32 v83, v46, v42, s56
    v_perm_b32 v84, v22, v18, s57
    v_perm_b32 v85, v30, v26, s57
    v_perm_b32 v86, v38, v34, s57
    v_perm_b32 v87, v46, v42, s57
    v_perm_b32 v88, v23, v19, s56
    v_perm_b32 v89, v31, v27, s56
    v_perm_b32 v90, v39, v35, s56
    v_perm_b32 v91, v47, v43, s56
    v_perm_b32 v92, v23, v19, s57
    v_perm_b32 v93, v31, v27, s57
    v_perm_b32 v94, v39, v35, s57
    v_perm_b32 v95, v47, v43, s57
    s_mov_b64 exec, s[50:51]
    s_add_u32 s49, s48, 28672
    buffer_load_dwordx4 v[16:19], v6, s[40:43], s49 offen offset:0
    buffer_load_dwordx4 v[20:23], v6, s[40:43], s49 offen offset:896
    buffer_load_dwordx4 v[24:27], v6, s[40:43], s49 offen offset:1792
    buffer_load_dwordx4 v[28:31], v6, s[40:43], s49 offen offset:2688
    s_add_u32 s49, s48, 32256
    s_waitcnt vmcnt(3)
    buffer_load_dwordx4 v[32:35], v6, s[40:43], s49 offen offset:0
    s_waitcnt vmcnt(3)
    buffer_load_dwordx4 v[36:39], v6, s[40:43], s49 offen offset:896
    s_waitcnt vmcnt(3)
    buffer_load_dwordx4 v[40:43], v6, s[40:43], s49 offen offset:1792
    s_waitcnt vmcnt(3)
    buffer_load_dwordx4 v[44:47], v6, s[40:43], s49 offen offset:2688
    s_mov_b64 exec, -1
    s_waitcnt vmcnt(0)
    v_perm_b32 v96, v20, v16, s56
    v_perm_b32 v97, v28, v24, s56
    v_perm_b32 v98, v36, v32, s56
    v_perm_b32 v99, v44, v40, s56
    v_perm_b32 v100, v20, v16, s57
    v_perm_b32 v101, v28, v24, s57
    v_perm_b32 v102, v36, v32, s57
    v_perm_b32 v103, v44, v40, s57
    v_perm_b32 v104, v21, v17, s56
    v_perm_b32 v105, v29, v25, s56
    v_perm_b32 v106, v37, v33, s56
    v_perm_b32 v107, v45, v41, s56
    v_perm_b32 v108, v21, v17, s57
    v_perm_b32 v109, v29, v25, s57
    v_perm_b32 v110, v37, v33, s57
    v_perm_b32 v111, v45, v41, s57
    v_perm_b32 v112, v22, v18, s56
    v_perm_b32 v113, v30, v26, s56
    v_perm_b32 v114, v38, v34, s56
    v_perm_b32 v115, v46, v42, s56
    v_perm_b32 v116, v22, v18, s57
    v_perm_b32 v117, v30, v26, s57
    v_perm_b32 v118, v38, v34, s57
    v_perm_b32 v119, v46, v42, s57
    v_perm_b32 v120, v23, v19, s56
    v_perm_b32 v121, v31, v27, s56
    v_perm_b32 v122, v39, v35, s56
    v_perm_b32 v123, v47, v43, s56
    v_perm_b32 v124, v23, v19, s57
    v_perm_b32 v125, v31, v27, s57
    v_perm_b32 v126, v39, v35, s57
    v_perm_b32 v127, v47, v43, s57
    s_mov_b64 exec, s[50:51]
    s_add_u32 s49, s48, 57344
    buffer_load_dwordx4 v[16:19], v6, s[40:43], s49 offen offset:0
    buffer_load_dwordx4 v[20:23], v6, s[40:43], s49 offen offset:896
    buffer_load_dwordx4 v[24:27], v6, s[40:43], s49 offen offset:1792
    buffer_load_dwordx4 v[28:31], v6, s[40:43], s49 offen offset:2688
    s_add_u32 s49, s48, 60928
    s_waitcnt vmcnt(3)
    buffer_load_dwordx4 v[32:35], v6, s[40:43], s49 offen offset:0
    s_waitcnt vmcnt(3)
    buffer_load_dwordx4 v[36:39], v6, s[40:43], s49 offen offset:896
    s_waitcnt vmcnt(3)
    buffer_load_dwordx4 v[40:43], v6, s[40:43], s49 offen offset:1792
    s_waitcnt vmcnt(3)
    buffer_load_dwordx4 v[44:47], v6, s[40:43], s49 offen offset:2688
    s_mov_b64 exec, -1
    s_waitcnt vmcnt(0)
    v_perm_b32 v128, v20, v16, s56
    v_perm_b32 v129, v28, v24, s56
    v_perm_b32 v130, v36, v32, s56
    v_perm_b32 v131, v44, v40, s56
    v_perm_b32 v132, v20, v16, s57
    v_perm_b32 v133, v28, v24, s57
    v_perm_b32 v134, v36, v32, s57
    v_perm_b32 v135, v44, v40, s57
    v_perm_b32 v136, v21, v17, s56
    v_perm_b32 v137, v29, v25, s56
    v_perm_b32 v138, v37, v33, s56
    v_perm_b32 v139, v45, v41, s56
    v_perm_b32 v140, v21, v17, s57
    v_perm_b32 v141, v29, v25, s57
    v_perm_b32 v142, v37, v33, s57
    v_perm_b32 v143, v45, v41, s57
    v_perm_b32 v144, v22, v18, s56
    v_perm_b32 v145, v30, v26, s56
    v_perm_b32 v146, v38, v34, s56
    v_perm_b32 v147, v46, v42, s56
    v_perm_b32 v148, v22, v18, s57
    v_perm_b32 v149, v30, v26, s57
    v_perm_b32 v150, v38, v34, s57
    v_perm_b32 v151, v46, v42, s57
    v_perm_b32 v152, v23, v19, s56
    v_perm_b32 v153, v31, v27, s56
    v_perm_b32 v154, v39, v35, s56
    v_perm_b32 v155, v47, v43, s56
    v_perm_b32 v156, v23, v19, s57
    v_perm_b32 v157, v31, v27, s57
    v_perm_b32 v158, v39, v35, s57
    v_perm_b32 v159, v47, v43, s57
    s_mov_b64 exec, s[50:51]
    s_add_u32 s49, s48, 86016
    buffer_load_dwordx4 v[16:19], v6, s[40:43], s49 offen offset:0
    buffer_load_dwordx4 v[20:23], v6, s[40:43], s49 offen offset:896
    buffer_load_dwordx4 v[24:27], v6, s[40:43], s49 offen offset:1792
    buffer_load_dwordx4 v[28:31], v6, s[40:43], s49 offen offset:2688
    s_add_u32 s49, s48, 89600
    s_waitcnt vmcnt(3)
    buffer_load_dwordx4 v[32:35], v6, s[40:43], s49 offen offset:0
    s_waitcnt vmcnt(3)
    buffer_load_dwordx4 v[36:39], v6, s[40:43], s49 offen offset:896
    s_waitcnt vmcnt(3)
    buffer_load_dwordx4 v[40:43], v6, s[40:43], s49 offen offset:1792
    s_waitcnt vmcnt(3)
    buffer_load_dwordx4 v[44:47], v6, s[40:43], s49 offen offset:2688
    s_mov_b64 exec, -1
    s_waitcnt vmcnt(0)
    v_perm_b32 v160, v20, v16, s56
    v_perm_b32 v161, v28, v24, s56
    v_perm_b32 v162, v36, v32, s56
    v_perm_b32 v163, v44, v40, s56
    v_perm_b32 v164, v20, v16, s57
    v_perm_b32 v165, v28, v24, s57
    v_perm_b32 v166, v36, v32, s57
    v_perm_b32 v167, v44, v40, s57
    v_perm_b32 v168, v21, v17, s56
    v_perm_b32 v169, v29, v25, s56
    v_perm_b32 v170, v37, v33, s56
    v_perm_b32 v171, v45, v41, s56
    v_perm_b32 v172, v21, v17, s57
    v_perm_b32 v173, v29, v25, s57
    v_perm_b32 v174, v37, v33, s57
    v_perm_b32 v175, v45, v41, s57
    v_perm_b32 v176, v22, v18, s56
    v_perm_b32 v177, v30, v26, s56
    v_perm_b32 v178, v38, v34, s56
    v_perm_b32 v179, v46, v42, s56
    v_perm_b32 v180, v22, v18, s57
    v_perm_b32 v181, v30, v26, s57
    v_perm_b32 v182, v38, v34, s57
    v_perm_b32 v183, v46, v42, s57
    v_perm_b32 v184, v23, v19, s56
    v_perm_b32 v185, v31, v27, s56
    v_perm_b32 v186, v39, v35, s56
    v_perm_b32 v187, v47, v43, s56
    v_perm_b32 v188, v23, v19, s57
    v_perm_b32 v189, v31, v27, s57
    v_perm_b32 v190, v39, v35, s57
    v_perm_b32 v191, v47, v43, s57
    s_mov_b32 s40, s20
    s_mov_b32 s41, s21
    s_mov_b32 s42, 1605632
    s_mov_b32 s43, 0x20000
    v_mul_u32_u24 v6, 28672, v3
    v_lshl_add_u32 v6, v2, 3, v6
    s_mul_i32 s48, s35, 114688
    s_cmp_lt_i32 s34, 0
    s_cbranch_scc1 L_sv_wskip
    s_lshl_b32 s49, s34, 7
    s_add_u32 s48, s48, s49
    s_add_u32 s49, s48, 0
    buffer_load_dwordx2 v[16:17], v6, s[40:43], s49 offen offset:0
    buffer_load_dwordx2 v[18:19], v6, s[40:43], s49 offen offset:3584
    s_add_u32 s49, s48, 7168
    buffer_load_dwordx2 v[20:21], v6, s[40:43], s49 offen offset:0
    buffer_load_dwordx2 v[22:23], v6, s[40:43], s49 offen offset:3584
    s_add_u32 s49, s48, 14336
    buffer_load_dwordx2 v[24:25], v6, s[40:43], s49 offen offset:0
    buffer_load_dwordx2 v[26:27], v6, s[40:43], s49 offen offset:3584
    s_add_u32 s49, s48, 21504
    buffer_load_dwordx2 v[28:29], v6, s[40:43], s49 offen offset:0
    buffer_load_dwordx2 v[30:31], v6, s[40:43], s49 offen offset:3584
    s_add_u32 s49, s48, 458752
    s_waitcnt vmcnt(7)
    buffer_load_dwordx2 v[32:33], v6, s[40:43], s49 offen offset:0
    s_waitcnt vmcnt(7)
    buffer_load_dwordx2 v[34:35], v6, s[40:43], s49 offen offset:3584
    s_add_u32 s49, s48, 465920
    s_waitcnt vmcnt(7)
    buffer_load_dwordx2 v[36:37], v6, s[40:43], s49 offen offset:0
    s_waitcnt vmcnt(7)
    buffer_load_dwordx2 v[38:39], v6, s[40:43], s49 offen offset:3584
    s_add_u32 s49, s48, 473088
    s_waitcnt vmcnt(7)
    buffer_load_dwordx2 v[40:41], v6, s[40:43], s49 offen offset:0
    s_waitcnt vmcnt(7)
    buffer_load_dwordx2 v[42:43], v6, s[40:43], s49 offen offset:3584
    s_add_u32 s49, s48, 480256
    s_waitcnt vmcnt(7)
    buffer_load_dwordx2 v[44:45], v6, s[40:43], s49 offen offset:0
    s_waitcnt vmcnt(7)
    buffer_load_dwordx2 v[46:47], v6, s[40:43], s49 offen offset:3584
    s_waitcnt vmcnt(0)
    v_perm_b32 v192, v18, v16, s56
    v_perm_b32 v193, v22, v20, s56
    v_perm_b32 v194, v26, v24, s56
    v_perm_b32 v195, v30, v28, s56
    v_perm_b32 v196, v18, v16, s57
    v_perm_b32 v197, v22, v20, s57
    v_perm_b32 v198, v26, v24, s57
    v_perm_b32 v199, v30, v28, s57
    v_perm_b32 v200, v19, v17, s56
    v_perm_b32 v201, v23, v21, s56
    v_perm_b32 v202, v27, v25, s56
    v_perm_b32 v203, v31, v29, s56
    v_perm_b32 v204, v19, v17, s57
    v_perm_b32 v205, v23, v21, s57
    v_perm_b32 v206, v27, v25, s57
    v_perm_b32 v207, v31, v29, s57
    v_perm_b32 v208, v34, v32, s56
    v_perm_b32 v209, v38, v36, s56
    v_perm_b32 v210, v42, v40, s56
    v_perm_b32 v211, v46, v44, s56
    v_perm_b32 v212, v34, v32, s57
    v_perm_b32 v213, v38, v36, s57
    v_perm_b32 v214, v42, v40, s57
    v_perm_b32 v215, v46, v44, s57
    v_perm_b32 v216, v35, v33, s56
    v_perm_b32 v217, v39, v37, s56
    v_perm_b32 v218, v43, v41, s56
    v_perm_b32 v219, v47, v45, s56
    v_perm_b32 v220, v35, v33, s57
    v_perm_b32 v221, v39, v37, s57
    v_perm_b32 v222, v43, v41, s57
    v_perm_b32 v223, v47, v45, s57
    s_add_u32 s49, s48, 917504
    buffer_load_dwordx2 v[16:17], v6, s[40:43], s49 offen offset:0
    buffer_load_dwordx2 v[18:19], v6, s[40:43], s49 offen offset:3584
    s_add_u32 s49, s48, 924672
    buffer_load_dwordx2 v[20:21], v6, s[40:43], s49 offen offset:0
    buffer_load_dwordx2 v[22:23], v6, s[40:43], s49 offen offset:3584
    s_add_u32 s49, s48, 931840
    buffer_load_dwordx2 v[24:25], v6, s[40:43], s49 offen offset:0
    buffer_load_dwordx2 v[26:27], v6, s[40:43], s49 offen offset:3584
    s_add_u32 s49, s48, 939008
    buffer_load_dwordx2 v[28:29], v6, s[40:43], s49 offen offset:0
    buffer_load_dwordx2 v[30:31], v6, s[40:43], s49 offen offset:3584
    s_add_u32 s49, s48, 1376256
    s_waitcnt vmcnt(7)
    buffer_load_dwordx2 v[32:33], v6, s[40:43], s49 offen offset:0
    s_waitcnt vmcnt(7)
    buffer_load_dwordx2 v[34:35], v6, s[40:43], s49 offen offset:3584
    s_add_u32 s49, s48, 1383424
    s_waitcnt vmcnt(7)
    buffer_load_dwordx2 v[36:37], v6, s[40:43], s49 offen offset:0
    s_waitcnt vmcnt(7)
    buffer_load_dwordx2 v[38:39], v6, s[40:43], s49 offen offset:3584
    s_add_u32 s49, s48, 1390592
    s_waitcnt vmcnt(7)
    buffer_load_dwordx2 v[40:41], v6, s[40:43], s49 offen offset:0
    s_waitcnt vmcnt(7)
    buffer_load_dwordx2 v[42:43], v6, s[40:43], s49 offen offset:3584
    s_add_u32 s49, s48, 1397760
    s_waitcnt vmcnt(7)
    buffer_load_dwordx2 v[44:45], v6, s[40:43], s49 offen offset:0
    s_waitcnt vmcnt(7)
    buffer_load_dwordx2 v[46:47], v6, s[40:43], s49 offen offset:3584
    s_waitcnt vmcnt(0)
    v_perm_b32 v224, v18, v16, s56
    v_perm_b32 v225, v22, v20, s56
    v_perm_b32 v226, v26, v24, s56
    v_perm_b32 v227, v30, v28, s56
    v_perm_b32 v228, v18, v16, s57
    v_perm_b32 v229, v22, v20, s57
    v_perm_b32 v230, v26, v24, s57
    v_perm_b32 v231, v30, v28, s57
    v_perm_b32 v232, v19, v17, s56
    v_perm_b32 v233, v23, v21, s56
    v_perm_b32 v234, v27, v25, s56
    v_perm_b32 v235, v31, v29, s56
    v_perm_b32 v236, v19, v17, s57
    v_perm_b32 v237, v23, v21, s57
    v_perm_b32 v238, v27, v25, s57
    v_perm_b32 v239, v31, v29, s57
    v_perm_b32 v240, v34, v32, s56
    v_perm_b32 v241, v38, v36, s56
    v_perm_b32 v242, v42, v40, s56
    v_perm_b32 v243, v46, v44, s56
    v_perm_b32 v244, v34, v32, s57
    v_perm_b32 v245, v38, v36, s57
    v_perm_b32 v246, v42, v40, s57
    v_perm_b32 v247, v46, v44, s57
    v_perm_b32 v248, v35, v33, s56
    v_perm_b32 v249, v39, v37, s56
    v_perm_b32 v250, v43, v41, s56
    v_perm_b32 v251, v47, v45, s56
    v_perm_b32 v252, v35, v33, s57
    v_perm_b32 v253, v39, v37, s57
    v_perm_b32 v254, v43, v41, s57
    v_perm_b32 v255, v47, v45, s57
L_sv_wskip:
    s_cmp_lg_u32 s2, 0
    s_cbranch_scc1 L_sv_noepw
    s_cmp_lg_u32 s35, 2
    s_cbranch_scc1 L_sv_noepw
    v_add_u32 v6, 462848, v4
    s_mov_b32 s51, 40000
L_sv_epoll:
    global_load_dwordx4 v[16:19], v6, s[32:33] sc1
    global_load_dwordx4 v[20:23], v6, s[32:33] offset:1024 sc1
    s_waitcnt vmcnt(0)
    v_xor_b32 v16, s92, v16
    v_xor_b32 v17, s93, v17
    v_xor_b32 v18, s92, v18
    v_xor_b32 v19, s93, v19
    v_xor_b32 v20, s92, v20
    v_xor_b32 v21, s93, v21
    v_xor_b32 v22, s92, v22
    v_xor_b32 v23, s93, v23
    v_or3_b32 v16, v16, v17, v18
    v_or3_b32 v16, v16, v19, v20
    v_or3_b32 v16, v16, v21, v22
    v_or_b32 v16, v16, v23
    v_cmp_ne_u32 vcc, 0, v16
    s_cbranch_vccz L_sv_eok
    s_sleep 16
    s_sub_u32 s51, s51, 1
    s_cmp_lg_u32 s51, 0
    s_cbranch_scc1 L_sv_epoll
L_sv_eok:
    v_mov_b32 v6, 458752
    v_mov_b32 v7, s93
    s_mov_b64 exec, 1
    global_store_dword v6, v7, s[32:33] offset:4 sc1
    s_mov_b64 exec, -1
L_sv_noepw:
    s_cmp_lg_u32 s35, 0
    s_cbranch_scc1 L_sv_tail
    s_mov_b32 s59, 800000
L_spin_11:
    ds_read_b32 v12, v5 offset:8
    s_waitcnt lgkmcnt(0)
    v_readfirstlane_b32 s50, v12
    s_nop 0
    s_cmp_eq_u32 s50, 4
    s_cbranch_scc1 L_spun_12
    s_sleep 1
    s_sub_u32 s59, s59, 1
    s_cmp_lg_u32 s59, 0
    s_cbranch_scc1 L_spin_11
L_spun_12:
    v_lshlrev_b32 v6, 6, v0
    ds_read_b128 v[48:51], v6 offset:8192
    ds_read_b128 v[52:55], v6 offset:8208
    ds_read_b128 v[56:59], v6 offset:8224
    ds_read_b128 v[60:63], v6 offset:8240
    s_lshl_b32 s48, s7, 7
    s_add_u32 s48, s48, 524288
    s_add_u32 s48, s48, s98
    s_add_u32 s44, s32, s48
    s_addc_u32 s45, s33, 0
    s_mov_b32 s46, 64
    s_mov_b32 s47, 0x20000
    s_mov_b32 s50, 0x3db8aa3b
    s_waitcnt lgkmcnt(0)
    v_lshlrev_b32 v16, 16, v48
    v_and_b32 v32, 0xffff0000, v48
    v_lshlrev_b32 v17, 16, v49
    v_and_b32 v33, 0xffff0000, v49
    v_lshlrev_b32 v18, 16, v50
    v_and_b32 v34, 0xffff0000, v50
    v_lshlrev_b32 v19, 16, v51
    v_and_b32 v35, 0xffff0000, v51
    v_lshlrev_b32 v20, 16, v52
    v_and_b32 v36, 0xffff0000, v52
    v_lshlrev_b32 v21, 16, v53
    v_and_b32 v37, 0xffff0000, v53
    v_lshlrev_b32 v22, 16, v54
    v_and_b32 v38, 0xffff0000, v54
    v_lshlrev_b32 v23, 16, v55
    v_and_b32 v39, 0xffff0000, v55
    v_lshlrev_b32 v24, 16, v56
    v_and_b32 v40, 0xffff0000, v56
    v_lshlrev_b32 v25, 16, v57
    v_and_b32 v41, 0xffff0000, v57
    v_lshlrev_b32 v26, 16, v58
    v_and_b32 v42, 0xffff0000, v58
    v_lshlrev_b32 v27, 16, v59
    v_and_b32 v43, 0xffff0000, v59
    v_lshlrev_b32 v28, 16, v60
    v_and_b32 v44, 0xffff0000, v60
    v_lshlrev_b32 v29, 16, v61
    v_and_b32 v45, 0xffff0000, v61
    v_lshlrev_b32 v30, 16, v62
    v_and_b32 v46, 0xffff0000, v62
    v_lshlrev_b32 v31, 16, v63
    v_and_b32 v47, 0xffff0000, v63
    v_max3_f32 v8, v16, v17, v18
    v_max3_f32 v8, v8, v19, v20
    v_max3_f32 v8, v8, v21, v22
    v_max3_f32 v8, v8, v23, v24
    v_max3_f32 v8, v8, v25, v26
    v_max3_f32 v8, v8, v27, v28
    v_max3_f32 v8, v8, v29, v30
    v_max_f32 v8, v8, v31
    v_max3_f32 v9, v32, v33, v34
    v_max3_f32 v9, v9, v35, v36
    v_max3_f32 v9, v9, v37, v38
    v_max3_f32 v9, v9, v39, v40
    v_max3_f32 v9, v9, v41, v42
    v_max3_f32 v9, v9, v43, v44
    v_max3_f32 v9, v9, v45, v46
    v_max_f32 v9, v9, v47
    s_nop 1
    v_max_f32_dpp v8, v8, v8 quad_perm:[1,0,3,2] row_mask:0xf bank_mask:0xf
    v_max_f32_dpp v9, v9, v9 quad_perm:[1,0,3,2] row_mask:0xf bank_mask:0xf
    s_nop 1
    v_max_f32_dpp v8, v8, v8 quad_perm:[2,3,0,1] row_mask:0xf bank_mask:0xf
    v_max_f32_dpp v9, v9, v9 quad_perm:[2,3,0,1] row_mask:0xf bank_mask:0xf
    s_nop 1
    v_max_f32_dpp v8, v8, v8 row_half_mirror row_mask:0xf bank_mask:0xf
    v_max_f32_dpp v9, v9, v9 row_half_mirror row_mask:0xf bank_mask:0xf
    s_nop 1
    v_max_f32_dpp v8, v8, v8 row_mirror row_mask:0xf bank_mask:0xf
    v_max_f32_dpp v9, v9, v9 row_mirror row_mask:0xf bank_mask:0xf
    v_mov_b32 v12, v8
    v_mov_b32 v13, v9
    s_nop 1
    v_permlane16_swap_b32 v8, v12
    v_permlane16_swap_b32 v9, v13
    s_nop 1
    v_max_f32 v8, v8, v12
    v_max_f32 v9, v9, v13
    v_mov_b32 v12, v8
    v_mov_b32 v13, v9
    s_nop 1
    v_permlane32_swap_b32 v8, v12
    v_permlane32_swap_b32 v9, v13
    s_nop 1
    v_max_f32 v8, v8, v12
    v_max_f32 v9, v9, v13
    v_sub_f32 v48, v16, v8
    v_sub_f32 v49, v17, v8
    v_sub_f32 v50, v18, v8
    v_sub_f32 v51, v19, v8
    v_sub_f32 v52, v20, v8
    v_sub_f32 v53, v21, v8
    v_sub_f32 v54, v22, v8
    v_sub_f32 v55, v23, v8
    v_sub_f32 v56, v24, v8
    v_sub_f32 v57, v25, v8
    v_sub_f32 v58, v26, v8
    v_sub_f32 v59, v27, v8
    v_sub_f32 v60, v28, v8
    v_sub_f32 v61, v29, v8
    v_sub_f32 v62, v30, v8
    v_sub_f32 v63, v31, v8
    v_mul_f32 v48, s50, v48
    v_mul_f32 v49, s50, v49
    v_mul_f32 v50, s50, v50
    v_mul_f32 v51, s50, v51
    v_mul_f32 v52, s50, v52
    v_mul_f32 v53, s50, v53
    v_mul_f32 v54, s50, v54
    v_mul_f32 v55, s50, v55
    v_mul_f32 v56, s50, v56
    v_mul_f32 v57, s50, v57
    v_mul_f32 v58, s50, v58
    v_mul_f32 v59, s50, v59
    v_mul_f32 v60, s50, v60
    v_mul_f32 v61, s50, v61
    v_mul_f32 v62, s50, v62
    v_mul_f32 v63, s50, v63
    v_exp_f32 v48, v48
    v_exp_f32 v49, v49
    v_exp_f32 v50, v50
    v_exp_f32 v51, v51
    v_exp_f32 v52, v52
    v_exp_f32 v53, v53
    v_exp_f32 v54, v54
    v_exp_f32 v55, v55
    v_exp_f32 v56, v56
    v_exp_f32 v57, v57
    v_exp_f32 v58, v58
    v_exp_f32 v59, v59
    v_exp_f32 v60, v60
    v_exp_f32 v61, v61
    v_exp_f32 v62, v62
    v_exp_f32 v63, v63
    s_nop 0
    v_add_f32 v10, v48, v49
    v_add_f32 v10, v10, v50
    v_add_f32 v10, v10, v51
    v_add_f32 v10, v10, v52
    v_add_f32 v10, v10, v53
    v_add_f32 v10, v10, v54
    v_add_f32 v10, v10, v55
    v_add_f32 v10, v10, v56
    v_add_f32 v10, v10, v57
    v_add_f32 v10, v10, v58
    v_add_f32 v10, v10, v59
    v_add_f32 v10, v10, v60
    v_add_f32 v10, v10, v61
    v_add_f32 v10, v10, v62
    v_add_f32 v10, v10, v63
    v_sub_f32 v48, v32, v9
    v_sub_f32 v49, v33, v9
    v_sub_f32 v50, v34, v9
    v_sub_f32 v51, v35, v9
    v_sub_f32 v52, v36, v9
    v_sub_f32 v53, v37, v9
    v_sub_f32 v54, v38, v9
    v_sub_f32 v55, v39, v9
    v_sub_f32 v56, v40, v9
    v_sub_f32 v57, v41, v9
    v_sub_f32 v58, v42, v9
    v_sub_f32 v59, v43, v9
    v_sub_f32 v60, v44, v9
    v_sub_f32 v61, v45, v9
    v_sub_f32 v62, v46, v9
    v_sub_f32 v63, v47, v9
    v_mul_f32 v48, s50, v48
    v_mul_f32 v49, s50, v49
    v_mul_f32 v50, s50, v50
    v_mul_f32 v51, s50, v51
    v_mul_f32 v52, s50, v52
    v_mul_f32 v53, s50, v53
    v_mul_f32 v54, s50, v54
    v_mul_f32 v55, s50, v55
    v_mul_f32 v56, s50, v56
    v_mul_f32 v57, s50, v57
    v_mul_f32 v58, s50, v58
    v_mul_f32 v59, s50, v59
    v_mul_f32 v60, s50, v60
    v_mul_f32 v61, s50, v61
    v_mul_f32 v62, s50, v62
    v_mul_f32 v63, s50, v63
    v_exp_f32 v48, v48
    v_exp_f32 v49, v49
    v_exp_f32 v50, v50
    v_exp_f32 v51, v51
    v_exp_f32 v52, v52
    v_exp_f32 v53, v53
    v_exp_f32 v54, v54
    v_exp_f32 v55, v55
    v_exp_f32 v56, v56
    v_exp_f32 v57, v57
    v_exp_f32 v58, v58
    v_exp_f32 v59, v59
    v_exp_f32 v60, v60
    v_exp_f32 v61, v61
    v_exp_f32 v62, v62
    v_exp_f32 v63, v63
    s_nop 0
    v_add_f32 v11, v48, v49
    v_add_f32 v11, v11, v50
    v_add_f32 v11, v11, v51
    v_add_f32 v11, v11, v52
    v_add_f32 v11, v11, v53
    v_add_f32 v11, v11, v54
    v_add_f32 v11, v11, v55
    v_add_f32 v11, v11, v56
    v_add_f32 v11, v11, v57
    v_add_f32 v11, v11, v58
    v_add_f32 v11, v11, v59
    v_add_f32 v11, v11, v60
    v_add_f32 v11, v11, v61
    v_add_f32 v11, v11, v62
    v_add_f32 v11, v11, v63
    s_nop 1
    v_add_f32_dpp v10, v10, v10 quad_perm:[1,0,3,2] row_mask:0xf bank_mask:0xf
    v_add_f32_dpp v11, v11, v11 quad_perm:[1,0,3,2] row_mask:0xf bank_mask:0xf
    s_nop 1
    v_add_f32_dpp v10, v10, v10 quad_perm:[2,3,0,1] row_mask:0xf bank_mask:0xf
    v_add_f32_dpp v11, v11, v11 quad_perm:[2,3,0,1] row_mask:0xf bank_mask:0xf
    s_nop 1
    v_add_f32_dpp v10, v10, v10 row_half_mirror row_mask:0xf bank_mask:0xf
    v_add_f32_dpp v11, v11, v11 row_half_mirror row_mask:0xf bank_mask:0xf
    s_nop 1
    v_add_f32_dpp v10, v10, v10 row_mirror row_mask:0xf bank_mask:0xf
    v_add_f32_dpp v11, v11, v11 row_mirror row_mask:0xf bank_mask:0xf
    v_mov_b32 v12, v10
    v_mov_b32 v13, v11
    s_nop 1
    v_permlane16_swap_b32 v10, v12
    v_permlane16_swap_b32 v11, v13
    s_nop 1
    v_add_f32 v10, v10, v12
    v_add_f32 v11, v11, v13
    v_mov_b32 v12, v10
    v_mov_b32 v13, v11
    s_nop 1
    v_permlane32_swap_b32 v10, v12
    v_permlane32_swap_b32 v11, v13
    s_nop 1
    v_add_f32 v10, v10, v12
    v_add_f32 v11, v11, v13
    s_getreg_b32 s91, hwreg(HW_REG_XCC_ID)
    s_and_b32 s91, s91, 0xff
    v_or_b32 v8, s91, v8
    v_min_u32 v8, -2, v8
    v_min_u32 v9, -2, v9
    v_min_u32 v10, -2, v10
    v_min_u32 v11, -2, v11
    s_lshl_b32 s48, s6, 4
    v_mov_b32 v7, 0
    s_mov_b64 exec, 1
    buffer_store_dwordx4 v[8:11], v7, s[44:47], s48 offen sc1
    s_mov_b64 exec, -1
    s_lshl_b32 s48, s4, 8
    s_add_u32 s48, s48, 462848
    v_and_b32 v12, 31, v0
    v_lshl_add_u32 v12, v12, 3, s48
    s_mov_b32 s51, 40000
L_sv_apoll:
    global_load_dwordx2 v[14:15], v12, s[32:33] sc1
    s_waitcnt vmcnt(0)
    v_xor_b32 v14, s92, v14
    v_xor_b32 v15, s93, v15
    v_or_b32 v14, v14, v15
    v_cmp_ne_u32 vcc, 0, v14
    s_cbranch_vccz L_sv_aok
    s_sleep 8
    s_sub_u32 s51, s51, 1
    s_cmp_lg_u32 s51, 0
    s_cbranch_scc1 L_sv_apoll
L_sv_aok:
    s_mov_b32 s59, 800000
L_spin_13:
    ds_read_b32 v12, v5 offset:20
    s_waitcnt lgkmcnt(0)
    v_readfirstlane_b32 s51, v12
    s_nop 0
    s_cmp_eq_u32 s51, 1
    s_cbranch_scc1 L_spun_14
    s_sleep 1
    s_sub_u32 s59, s59, 1
    s_cmp_lg_u32 s59, 0
    s_cbranch_scc1 L_spin_13
L_spun_14:
    s_mov_b32 s51, 40000
L_poll_15:
    buffer_load_dwordx4 v[48:51], v7, s[44:47], 0 offen offset:0 sc1
    buffer_load_dwordx4 v[52:55], v7, s[44:47], 0 offen offset:16 sc1
    buffer_load_dwordx4 v[56:59], v7, s[44:47], 0 offen offset:32 sc1
    buffer_load_dwordx4 v[60:63], v7, s[44:47], 0 offen offset:48 sc1
    s_waitcnt vmcnt(0)
    v_max3_u32 v12, v48, v49, v50
    v_max3_u32 v12, v12, v51, v52
    v_max3_u32 v12, v12, v53, v54
    v_max3_u32 v12, v12, v55, v56
    v_max3_u32 v12, v12, v57, v58
    v_max3_u32 v12, v12, v59, v60
    v_max3_u32 v12, v12, v61, v62
    v_max_u32 v12, v12, v63
    v_cmp_eq_u32 vcc, -1, v12
    s_cbranch_vccz L_polled_16
    s_sleep 8
    s_sub_u32 s51, s51, 1
    s_cmp_lg_u32 s51, 0
    s_cbranch_scc1 L_poll_15
L_polled_16:
    v_xor_b32 v12, v48, v52
    v_xor_b32 v13, v48, v56
    v_xor_b32 v14, v48, v60
    v_or3_b32 v12, v12, v13, v14
    v_and_b32 v12, 0xffff, v12
    ds_write_b32 v5, v12 offset:32
    v_and_b32 v48, 0xffff0000, v48
    v_and_b32 v52, 0xffff0000, v52
    v_and_b32 v56, 0xffff0000, v56
    v_and_b32 v60, 0xffff0000, v60
    v_max3_f32 v8, v48, v52, v56
    v_max_f32 v8, v8, v60
    v_max3_f32 v9, v49, v53, v57
    v_max_f32 v9, v9, v61
    v_sub_f32 v48, v48, v8
    v_mul_f32 v48, s50, v48
    v_exp_f32 v48, v48
    v_sub_f32 v52, v52, v8
    v_mul_f32 v52, s50, v52
    v_exp_f32 v52, v52
    v_sub_f32 v56, v56, v8
    v_mul_f32 v56, s50, v56
    v_exp_f32 v56, v56
    v_sub_f32 v60, v60, v8
    v_mul_f32 v60, s50, v60
    v_exp_f32 v60, v60
    s_nop 0
    v_mul_f32 v10, v48, v50
    v_fmac_f32 v10, v52, v54
    v_fmac_f32 v10, v56, v58
    v_fmac_f32 v10, v60, v62
    v_rcp_f32 v10, v10
    v_sub_f32 v49, v49, v9
    v_mul_f32 v49, s50, v49
    v_exp_f32 v49, v49
    v_sub_f32 v53, v53, v9
    v_mul_f32 v53, s50, v53
    v_exp_f32 v53, v53
    v_sub_f32 v57, v57, v9
    v_mul_f32 v57, s50, v57
    v_exp_f32 v57, v57
    v_sub_f32 v61, v61, v9
    v_mul_f32 v61, s50, v61
    v_exp_f32 v61, v61
    s_nop 0
    v_mul_f32 v11, v49, v51
    v_fmac_f32 v11, v53, v55
    v_fmac_f32 v11, v57, v59
    v_fmac_f32 v11, v61, v63
    v_rcp_f32 v11, v11
    v_sub_f32 v16, v16, v8
    v_sub_f32 v17, v17, v8
    v_sub_f32 v18, v18, v8
    v_sub_f32 v19, v19, v8
    v_sub_f32 v20, v20, v8
    v_sub_f32 v21, v21, v8
    v_sub_f32 v22, v22, v8
    v_sub_f32 v23, v23, v8
    v_sub_f32 v24, v24, v8
    v_sub_f32 v25, v25, v8
    v_sub_f32 v26, v26, v8
    v_sub_f32 v27, v27, v8
    v_sub_f32 v28, v28, v8
    v_sub_f32 v29, v29, v8
    v_sub_f32 v30, v30, v8
    v_sub_f32 v31, v31, v8
    v_mul_f32 v16, s50, v16
    v_mul_f32 v17, s50, v17
    v_mul_f32 v18, s50, v18
    v_mul_f32 v19, s50, v19
    v_mul_f32 v20, s50, v20
    v_mul_f32 v21, s50, v21
    v_mul_f32 v22, s50, v22
    v_mul_f32 v23, s50, v23
    v_mul_f32 v24, s50, v24
    v_mul_f32 v25, s50, v25
    v_mul_f32 v26, s50, v26
    v_mul_f32 v27, s50, v27
    v_mul_f32 v28, s50, v28
    v_mul_f32 v29, s50, v29
    v_mul_f32 v30, s50, v30
    v_mul_f32 v31, s50, v31
    v_exp_f32 v16, v16
    v_exp_f32 v17, v17
    v_exp_f32 v18, v18
    v_exp_f32 v19, v19
    v_exp_f32 v20, v20
    v_exp_f32 v21, v21
    v_exp_f32 v22, v22
    v_exp_f32 v23, v23
    v_exp_f32 v24, v24
    v_exp_f32 v25, v25
    v_exp_f32 v26, v26
    v_exp_f32 v27, v27
    v_exp_f32 v28, v28
    v_exp_f32 v29, v29
    v_exp_f32 v30, v30
    v_exp_f32 v31, v31
    s_nop 0
    v_mul_f32 v16, v16, v10
    v_mul_f32 v17, v17, v10
    v_mul_f32 v18, v18, v10
    v_mul_f32 v19, v19, v10
    v_mul_f32 v20, v20, v10
    v_mul_f32 v21, v21, v10
    v_mul_f32 v22, v22, v10
    v_mul_f32 v23, v23, v10
    v_mul_f32 v24, v24, v10
    v_mul_f32 v25, v25, v10
    v_mul_f32 v26, v26, v10
    v_mul_f32 v27, v27, v10
    v_mul_f32 v28, v28, v10
    v_mul_f32 v29, v29, v10
    v_mul_f32 v30, v30, v10
    v_mul_f32 v31, v31, v10
    v_cvt_pk_bf16_f32 v48, v16, v18
    v_cvt_pk_bf16_f32 v49, v20, v22
    v_cvt_pk_bf16_f32 v50, v24, v26
    v_cvt_pk_bf16_f32 v51, v28, v30
    v_cvt_pk_bf16_f32 v52, v17, v19
    v_cvt_pk_bf16_f32 v53, v21, v23
    v_cvt_pk_bf16_f32 v54, v25, v27
    v_cvt_pk_bf16_f32 v55, v29, v31
    v_sub_f32 v32, v32, v9
    v_sub_f32 v33, v33, v9
    v_sub_f32 v34, v34, v9
    v_sub_f32 v35, v35, v9
    v_sub_f32 v36, v36, v9
    v_sub_f32 v37, v37, v9
    v_sub_f32 v38, v38, v9
    v_sub_f32 v39, v39, v9
    v_sub_f32 v40, v40, v9
    v_sub_f32 v41, v41, v9
    v_sub_f32 v42, v42, v9
    v_sub_f32 v43, v43, v9
    v_sub_f32 v44, v44, v9
    v_sub_f32 v45, v45, v9
    v_sub_f32 v46, v46, v9
    v_sub_f32 v47, v47, v9
    v_mul_f32 v32, s50, v32
    v_mul_f32 v33, s50, v33
    v_mul_f32 v34, s50, v34
    v_mul_f32 v35, s50, v35
    v_mul_f32 v36, s50, v36
    v_mul_f32 v37, s50, v37
    v_mul_f32 v38, s50, v38
    v_mul_f32 v39, s50, v39
    v_mul_f32 v40, s50, v40
    v_mul_f32 v41, s50, v41
    v_mul_f32 v42, s50, v42
    v_mul_f32 v43, s50, v43
    v_mul_f32 v44, s50, v44
    v_mul_f32 v45, s50, v45
    v_mul_f32 v46, s50, v46
    v_mul_f32 v47, s50, v47
    v_exp_f32 v32, v32
    v_exp_f32 v33, v33
    v_exp_f32 v34, v34
    v_exp_f32 v35, v35
    v_exp_f32 v36, v36
    v_exp_f32 v37, v37
    v_exp_f32 v38, v38
    v_exp_f32 v39, v39
    v_exp_f32 v40, v40
    v_exp_f32 v41, v41
    v_exp_f32 v42, v42
    v_exp_f32 v43, v43
    v_exp_f32 v44, v44
    v_exp_f32 v45, v45
    v_exp_f32 v46, v46
    v_exp_f32 v47, v47
    s_nop 0
    v_mul_f32 v32, v32, v11
    v_mul_f32 v33, v33, v11
    v_mul_f32 v34, v34, v11
    v_mul_f32 v35, v35, v11
    v_mul_f32 v36, v36, v11
    v_mul_f32 v37, v37, v11
    v_mul_f32 v38, v38, v11
    v_mul_f32 v39, v39, v11
    v_mul_f32 v40, v40, v11
    v_mul_f32 v41, v41, v11
    v_mul_f32 v42, v42, v11
    v_mul_f32 v43, v43, v11
    v_mul_f32 v44, v44, v11
    v_mul_f32 v45, v45, v11
    v_mul_f32 v46, v46, v11
    v_mul_f32 v47, v47, v11
    v_cvt_pk_bf16_f32 v56, v32, v34
    v_cvt_pk_bf16_f32 v57, v36, v38
    v_cvt_pk_bf16_f32 v58, v40, v42
    v_cvt_pk_bf16_f32 v59, v44, v46
    v_cvt_pk_bf16_f32 v60, v33, v35
    v_cvt_pk_bf16_f32 v61, v37, v39
    v_cvt_pk_bf16_f32 v62, v41, v43
    v_cvt_pk_bf16_f32 v63, v45, v47
    ds_write_b128 v6, v[48:51] offset:16384
    ds_write_b128 v6, v[52:55] offset:16400
    ds_write_b128 v6, v[56:59] offset:16416
    ds_write_b128 v6, v[60:63] offset:16432
    v_mov_b32 v7, 1
    s_waitcnt lgkmcnt(0)
    ds_write_b32 v5, v7 offset:12
    s_mov_b32 s36, s8
    s_mov_b32 s37, s9
    s_mov_b32 s38, 7168
    s_mov_b32 s39, 0x20000
    s_mul_i32 s48, s4, 896
    buffer_load_dwordx4 v[56:59], v4, s[36:39], s48 offen
    s_mov_b32 s36, s26
    s_mov_b32 s37, s27
    s_mov_b32 s38, 896
    s_mov_b32 s39, 0x20000
    v_and_b32 v7, 3, v0
    v_lshlrev_b32 v7, 3, v7
    s_max_i32 s48, s34, 0
    s_lshl_b32 s48, s48, 5
    buffer_load_dwordx2 v[60:61], v7, s[36:39], s48 offen
    s_waitcnt vmcnt(0)
L_sv_tail:
    v_lshlrev_b32 v6, 4, v3
    s_lshl_b32 s48, s35, 8
    v_add_u32 v6, s48, v6
    s_barrier
    s_barrier
    ds_read_b128 v[16:19], v6 offset:32768
    ds_read_b128 v[20:23], v6 offset:32832
    ds_read_b128 v[24:27], v6 offset:32896
    ds_read_b128 v[28:31], v6 offset:32960
    s_lshl_b32 s48, s35, 9
    v_lshl_add_u32 v7, v2, 5, s48
    s_waitcnt lgkmcnt(3)
    v_mfma_f32_16x16x32_bf16 v[32:35], v[16:19], v[64:67], 0
    v_mfma_f32_16x16x32_bf16 v[36:39], v[16:19], v[68:71], 0
    v_mfma_f32_16x16x32_bf16 v[40:43], v[16:19], v[72:75], 0
    v_mfma_f32_16x16x32_bf16 v[44:47], v[16:19], v[76:79], 0
    v_mfma_f32_16x16x32_bf16 v[48:51], v[16:19], v[80:83], 0
    v_mfma_f32_16x16x32_bf16 v[52:55], v[16:19], v[84:87], 0
    v_mfma_f32_16x16x32_bf16 v[8:11], v[16:19], v[88:91], 0
    v_mfma_f32_16x16x32_bf16 v[12:15], v[16:19], v[92:95], 0
    s_waitcnt lgkmcnt(2)
    v_mfma_f32_16x16x32_bf16 v[32:35], v[20:23], v[96:99], v[32:35]
    v_mfma_f32_16x16x32_bf16 v[36:39], v[20:23], v[100:103], v[36:39]
    v_mfma_f32_16x16x32_bf16 v[40:43], v[20:23], v[104:107], v[40:43]
    v_mfma_f32_16x16x32_bf16 v[44:47], v[20:23], v[108:111], v[44:47]
    v_mfma_f32_16x16x32_bf16 v[48:51], v[20:23], v[112:115], v[48:51]
    v_mfma_f32_16x16x32_bf16 v[52:55], v[20:23], v[116:119], v[52:55]
    v_mfma_f32_16x16x32_bf16 v[8:11], v[20:23], v[120:123], v[8:11]
    v_mfma_f32_16x16x32_bf16 v[12:15], v[20:23], v[124:127], v[12:15]
    s_waitcnt lgkmcnt(1)
    v_mfma_f32_16x16x32_bf16 v[32:35], v[24:27], v[128:131], v[32:35]
    v_mfma_f32_16x16x32_bf16 v[36:39], v[24:27], v[132:135], v[36:39]
    v_mfma_f32_16x16x32_bf16 v[40:43], v[24:27], v[136:139], v[40:43]
    v_mfma_f32_16x16x32_bf16 v[44:47], v[24:27], v[140:143], v[44:47]
    v_mfma_f32_16x16x32_bf16 v[48:51], v[24:27], v[144:147], v[48:51]
    v_mfma_f32_16x16x32_bf16 v[52:55], v[24:27], v[148:151], v[52:55]
    v_mfma_f32_16x16x32_bf16 v[8:11], v[24:27], v[152:155], v[8:11]
    v_mfma_f32_16x16x32_bf16 v[12:15], v[24:27], v[156:159], v[12:15]
    s_waitcnt lgkmcnt(0)
    v_mfma_f32_16x16x32_bf16 v[32:35], v[28:31], v[160:163], v[32:35]
    v_mfma_f32_16x16x32_bf16 v[36:39], v[28:31], v[164:167], v[36:39]
    v_mfma_f32_16x16x32_bf16 v[40:43], v[28:31], v[168:171], v[40:43]
    v_mfma_f32_16x16x32_bf16 v[44:47], v[28:31], v[172:175], v[44:47]
    v_mfma_f32_16x16x32_bf16 v[48:51], v[28:31], v[176:179], v[48:51]
    v_mfma_f32_16x16x32_bf16 v[52:55], v[28:31], v[180:183], v[52:55]
    v_mfma_f32_16x16x32_bf16 v[8:11], v[28:31], v[184:187], v[8:11]
    v_mfma_f32_16x16x32_bf16 v[12:15], v[28:31], v[188:191], v[12:15]
    s_nop 1
    v_mov_b32 v16, v32
    v_mov_b32 v17, v36
    v_mov_b32 v18, v40
    v_mov_b32 v19, v44
    v_mov_b32 v20, v48
    v_mov_b32 v21, v52
    v_mov_b32 v22, v8
    v_mov_b32 v23, v12
    ds_write_b128 v7, v[16:19] offset:33792
    ds_write_b128 v7, v[20:23] offset:33808
    s_waitcnt lgkmcnt(0)
    s_barrier
    s_cmp_lg_u32 s35, 0
    s_cbranch_scc1 L_sv_skip2
    ds_read_b128 v[16:19], v4 offset:33792
    ds_read_b128 v[20:23], v4 offset:34304
    ds_read_b128 v[24:27], v4 offset:34816
    ds_read_b128 v[28:31], v4 offset:35328
    s_mul_i32 s48, s4, 14336
    s_add_u32 s48, s48, 1114112
    s_add_u32 s48, s48, s98
    s_add_u32 s44, s32, s48
    s_addc_u32 s45, s33, 0
    s_mov_b32 s46, 14336
    s_mov_b32 s47, 0x20000
    s_mul_i32 s48, s5, 1792
    s_lshl_b32 s49, s6, 9
    s_add_u32 s48, s48, s49
    s_cmp_eq_u32 s6, 3
    s_cselect_b32 s50, 0xffff, -1
    s_mov_b32 s51, 0
    v_lshlrev_b32 v7, 5, v0
    s_waitcnt lgkmcnt(0)
    v_pk_add_f32 v[16:17], v[16:17], v[20:21]
    v_pk_add_f32 v[24:25], v[24:25], v[28:29]
    v_pk_add_f32 v[18:19], v[18:19], v[22:23]
    v_pk_add_f32 v[26:27], v[26:27], v[30:31]
    v_pk_add_f32 v[16:17], v[16:17], v[24:25]
    v_pk_add_f32 v[18:19], v[18:19], v[26:27]
    s_mov_b64 exec, s[50:51]
    buffer_store_dwordx4 v[16:19], v4, s[44:47], s48 offen sc1
    s_mov_b64 exec, -1
    s_cmp_lt_i32 s34, 0
    s_cbranch_scc1 L_sv_skip2
    s_mov_b64 exec, s[52:53]
    s_mov_b32 s37, 3584
    s_mov_b32 s38, 7168
    s_mov_b32 s39, 10752
    s_mov_b32 s51, 40000
    v_lshlrev_b32 v32, 16, v56
    v_and_b32 v33, 0xffff0000, v56
    v_lshlrev_b32 v34, 16, v57
    v_and_b32 v35, 0xffff0000, v57
    v_lshlrev_b32 v36, 16, v58
    v_and_b32 v37, 0xffff0000, v58
    v_lshlrev_b32 v38, 16, v59
    v_and_b32 v39, 0xffff0000, v59
L_sv_appoll:
    buffer_load_dwordx4 v[64:67], v7, s[44:47], 0 offen offset:0 sc1
    buffer_load_dwordx4 v[68:71], v7, s[44:47], 0 offen offset:16 sc1
    buffer_load_dwordx4 v[72:75], v7, s[44:47], 0 offen offset:1792 sc1
    buffer_load_dwordx4 v[76:79], v7, s[44:47], 0 offen offset:1808 sc1
    buffer_load_dwordx4 v[80:83], v7, s[44:47], s37 offen offset:0 sc1
    buffer_load_dwordx4 v[84:87], v7, s[44:47], s37 offen offset:16 sc1
    buffer_load_dwordx4 v[88:91], v7, s[44:47], s37 offen offset:1792 sc1
    buffer_load_dwordx4 v[92:95], v7, s[44:47], s37 offen offset:1808 sc1
    buffer_load_dwordx4 v[96:99], v7, s[44:47], s38 offen offset:0 sc1
    buffer_load_dwordx4 v[100:103], v7, s[44:47], s38 offen offset:16 sc1
    buffer_load_dwordx4 v[104:107], v7, s[44:47], s38 offen offset:1792 sc1
    buffer_load_dwordx4 v[108:111], v7, s[44:47], s38 offen offset:1808 sc1
    buffer_load_dwordx4 v[112:115], v7, s[44:47], s39 offen offset:0 sc1
    buffer_load_dwordx4 v[116:119], v7, s[44:47], s39 offen offset:16 sc1
    buffer_load_dwordx4 v[120:123], v7, s[44:47], s39 offen offset:1792 sc1
    buffer_load_dwordx4 v[124:127], v7, s[44:47], s39 offen offset:1808 sc1
    s_waitcnt vmcnt(12)
    v_pk_add_f32 v[64:65], v[64:65], v[72:73]
    v_pk_add_f32 v[66:67], v[66:67], v[74:75]
    v_pk_add_f32 v[68:69], v[68:69], v[76:77]
    v_pk_add_f32 v[70:71], v[70:71], v[78:79]
    s_waitcnt vmcnt(8)
    v_pk_add_f32 v[80:81], v[80:81], v[88:89]
    v_pk_add_f32 v[82:83], v[82:83], v[90:91]
    v_pk_add_f32 v[84:85], v[84:85], v[92:93]
    v_pk_add_f32 v[86:87], v[86:87], v[94:95]
    v_pk_add_f32 v[64:65], v[64:65], v[80:81]
    v_pk_add_f32 v[66:67], v[66:67], v[82:83]
    v_pk_add_f32 v[68:69], v[68:69], v[84:85]
    v_pk_add_f32 v[70:71], v[70:71], v[86:87]
    s_waitcnt vmcnt(4)
    v_pk_add_f32 v[96:97], v[96:97], v[104:105]
    v_pk_add_f32 v[98:99], v[98:99], v[106:107]
    v_pk_add_f32 v[100:101], v[100:101], v[108:109]
    v_pk_add_f32 v[102:103], v[102:103], v[110:111]
    s_waitcnt vmcnt(0)
    v_pk_add_f32 v[112:113], v[112:113], v[120:121]
    v_pk_add_f32 v[114:115], v[114:115], v[122:123]
    v_pk_add_f32 v[116:117], v[116:117], v[124:125]
    v_pk_add_f32 v[118:119], v[118:119], v[126:127]
    v_pk_add_f32 v[96:97], v[96:97], v[112:113]
    v_pk_add_f32 v[98:99], v[98:99], v[114:115]
    v_pk_add_f32 v[100:101], v[100:101], v[116:117]
    v_pk_add_f32 v[102:103], v[102:103], v[118:119]
    v_pk_add_f32 v[64:65], v[64:65], v[96:97]
    v_pk_add_f32 v[66:67], v[66:67], v[98:99]
    v_pk_add_f32 v[68:69], v[68:69], v[100:101]
    v_pk_add_f32 v[70:71], v[70:71], v[102:103]
    v_pk_add_f32 v[72:73], v[64:65], v[66:67]
    v_pk_add_f32 v[74:75], v[68:69], v[70:71]
    v_pk_add_f32 v[72:73], v[72:73], v[74:75]
    v_cmp_u_f32 vcc, v72, v73
    s_cbranch_vccz L_sv_apok
    s_sub_u32 s51, s51, 1
    s_cmp_lg_u32 s51, 0
    s_cbranch_scc1 L_sv_appoll
L_sv_apok:
    s_mov_b64 exec, -1
    v_cvt_pk_bf16_f32 v16, v64, v65
    v_cvt_pk_bf16_f32 v17, v66, v67
    v_cvt_pk_bf16_f32 v18, v68, v69
    v_cvt_pk_bf16_f32 v19, v70, v71
    v_lshlrev_b32 v64, 16, v16
    v_and_b32 v65, 0xffff0000, v16
    v_lshlrev_b32 v66, 16, v17
    v_and_b32 v67, 0xffff0000, v17
    v_lshlrev_b32 v68, 16, v18
    v_and_b32 v69, 0xffff0000, v18
    v_lshlrev_b32 v70, 16, v19
    v_and_b32 v71, 0xffff0000, v19
    v_pk_add_f32 v[64:65], v[64:65], v[32:33]
    v_pk_add_f32 v[66:67], v[66:67], v[34:35]
    v_pk_add_f32 v[68:69], v[68:69], v[36:37]
    v_pk_add_f32 v[70:71], v[70:71], v[38:39]
    v_cvt_pk_bf16_f32 v16, v64, v65
    v_cvt_pk_bf16_f32 v17, v66, v67
    v_cvt_pk_bf16_f32 v18, v68, v69
    v_cvt_pk_bf16_f32 v19, v70, v71
    v_lshlrev_b32 v64, 16, v16
    v_and_b32 v65, 0xffff0000, v16
    v_lshlrev_b32 v66, 16, v17
    v_and_b32 v67, 0xffff0000, v17
    v_lshlrev_b32 v68, 16, v18
    v_and_b32 v69, 0xffff0000, v18
    v_lshlrev_b32 v70, 16, v19
    v_and_b32 v71, 0xffff0000, v19
    v_readfirstlane_b32 s50, v64
    s_nop 1
    v_subrev_f32 v72, s50, v64
    v_subrev_f32 v73, s50, v65
    v_subrev_f32 v74, s50, v66
    v_subrev_f32 v75, s50, v67
    v_subrev_f32 v76, s50, v68
    v_subrev_f32 v77, s50, v69
    v_subrev_f32 v78, s50, v70
    v_subrev_f32 v79, s50, v71
    v_pk_add_f32 v[84:85], v[72:73], v[74:75]
    v_pk_add_f32 v[86:87], v[76:77], v[78:79]
    v_mul_f32 v81, v72, v72
    v_mul_f32 v83, v73, v73
    v_pk_add_f32 v[84:85], v[84:85], v[86:87]
    v_fmac_f32 v81, v74, v74
    v_fmac_f32 v83, v75, v75
    v_fmac_f32 v81, v76, v76
    v_fmac_f32 v83, v77, v77
    v_fmac_f32 v81, v78, v78
    v_fmac_f32 v83, v79, v79
    v_add_f32 v80, v84, v85
    v_add_f32 v81, v81, v83
    v_cndmask_b32 v80, 0, v80, s[52:53]
    v_cndmask_b32 v81, 0, v81, s[52:53]
    s_nop 1
    v_add_f32_dpp v80, v80, v80 quad_perm:[1,0,3,2] row_mask:0xf bank_mask:0xf
    v_add_f32_dpp v81, v81, v81 quad_perm:[1,0,3,2] row_mask:0xf bank_mask:0xf
    s_nop 1
    v_add_f32_dpp v80, v80, v80 quad_perm:[2,3,0,1] row_mask:0xf bank_mask:0xf
    v_add_f32_dpp v81, v81, v81 quad_perm:[2,3,0,1] row_mask:0xf bank_mask:0xf
    s_nop 1
    v_add_f32_dpp v80, v80, v80 row_half_mirror row_mask:0xf bank_mask:0xf
    v_add_f32_dpp v81, v81, v81 row_half_mirror row_mask:0xf bank_mask:0xf
    s_nop 1
    v_add_f32_dpp v80, v80, v80 row_mirror row_mask:0xf bank_mask:0xf
    v_add_f32_dpp v81, v81, v81 row_mirror row_mask:0xf bank_mask:0xf
    v_mov_b32 v82, v80
    v_mov_b32 v83, v81
    s_nop 1
    v_permlane16_swap_b32 v80, v82
    v_permlane16_swap_b32 v81, v83
    s_nop 1
    v_add_f32 v80, v80, v82
    v_add_f32 v81, v81, v83
    v_mov_b32 v82, v80
    v_mov_b32 v83, v81
    s_nop 1
    v_permlane32_swap_b32 v80, v82
    v_permlane32_swap_b32 v81, v83
    s_nop 1
    v_add_f32 v80, v80, v82
    v_add_f32 v81, v81, v83
    v_mul_f32 v80, 0x3b124925, v80
    v_mul_f32 v81, 0x3b124925, v81
    v_fma_f32 v81, -v80, v80, v81
    v_add_f32 v80, s50, v80
    v_max_f32 v81, 0, v81
    v_cvt_pk_bf16_f32 v82, v80, v81
    v_lshlrev_b32 v80, 16, v82
    v_and_b32 v81, 0xffff0000, v82
    v_add_f32 v81, 0x3727c5ac, v81
    v_cvt_pk_bf16_f32 v81, v81, v81
    v_lshlrev_b32 v81, 16, v81
    v_sqrt_f32 v81, v81
    v_sub_f32 v72, v64, v80
    v_sub_f32 v73, v65, v80
    v_sub_f32 v74, v66, v80
    v_sub_f32 v75, v67, v80
    v_sub_f32 v76, v68, v80
    v_sub_f32 v77, v69, v80
    v_sub_f32 v78, v70, v80
    v_sub_f32 v79, v71, v80
    v_cvt_pk_bf16_f32 v81, v81, v81
    v_lshlrev_b32 v81, 16, v81
    v_rcp_f32 v81, v81
    v_cvt_pk_bf16_f32 v16, v72, v73
    v_cvt_pk_bf16_f32 v17, v74, v75
    v_cvt_pk_bf16_f32 v18, v76, v77
    v_cvt_pk_bf16_f32 v19, v78, v79
    v_lshlrev_b32 v72, 16, v16
    v_and_b32 v73, 0xffff0000, v16
    v_lshlrev_b32 v74, 16, v17
    v_and_b32 v75, 0xffff0000, v17
    v_lshlrev_b32 v76, 16, v18
    v_and_b32 v77, 0xffff0000, v18
    v_lshlrev_b32 v78, 16, v19
    v_and_b32 v79, 0xffff0000, v19
    v_mul_f32 v72, v72, v81
    v_mul_f32 v73, v73, v81
    v_mul_f32 v74, v74, v81
    v_mul_f32 v75, v75, v81
    v_mul_f32 v76, v76, v81
    v_mul_f32 v77, v77, v81
    v_mul_f32 v78, v78, v81
    v_mul_f32 v79, v79, v81
    v_cvt_pk_bf16_f32 v16, v72, v73
    v_cvt_pk_bf16_f32 v17, v74, v75
    v_cvt_pk_bf16_f32 v18, v76, v77
    v_cvt_pk_bf16_f32 v19, v78, v79
    s_mov_b64 exec, s[52:53]
    ds_write_b128 v4, v[16:19] offset:35840
    ds_write_b128 v7, v[64:67] offset:36864
    ds_write_b128 v7, v[68:71] offset:36880
    s_mov_b64 exec, -1
    s_waitcnt lgkmcnt(0)
L_sv_skip2:
    s_barrier
    v_lshlrev_b32 v6, 4, v3
    s_lshl_b32 s48, s35, 6
    v_add_u32 v6, s48, v6
    ds_read_b128 v[16:19], v6 offset:35840
    ds_read_b128 v[20:23], v6 offset:36096
    ds_read_b128 v[24:27], v6 offset:36352
    ds_read_b128 v[28:31], v6 offset:36608
    s_lshl_b32 s48, s35, 8
    v_lshl_add_u32 v7, v2, 4, s48
    s_waitcnt lgkmcnt(3)
    v_mfma_f32_16x16x32_bf16 v[32:35], v[16:19], v[192:195], 0
    v_mfma_f32_16x16x32_bf16 v[36:39], v[16:19], v[196:199], 0
    v_mfma_f32_16x16x32_bf16 v[40:43], v[16:19], v[200:203], 0
    v_mfma_f32_16x16x32_bf16 v[44:47], v[16:19], v[204:207], 0
    s_waitcnt lgkmcnt(2)
    v_mfma_f32_16x16x32_bf16 v[32:35], v[20:23], v[208:211], v[32:35]
    v_mfma_f32_16x16x32_bf16 v[36:39], v[20:23], v[212:215], v[36:39]
    v_mfma_f32_16x16x32_bf16 v[40:43], v[20:23], v[216:219], v[40:43]
    v_mfma_f32_16x16x32_bf16 v[44:47], v[20:23], v[220:223], v[44:47]
    s_waitcnt lgkmcnt(1)
    v_mfma_f32_16x16x32_bf16 v[32:35], v[24:27], v[224:227], v[32:35]
    v_mfma_f32_16x16x32_bf16 v[36:39], v[24:27], v[228:231], v[36:39]
    v_mfma_f32_16x16x32_bf16 v[40:43], v[24:27], v[232:235], v[40:43]
    v_mfma_f32_16x16x32_bf16 v[44:47], v[24:27], v[236:239], v[44:47]
    s_waitcnt lgkmcnt(0)
    v_mfma_f32_16x16x32_bf16 v[32:35], v[28:31], v[240:243], v[32:35]
    v_mfma_f32_16x16x32_bf16 v[36:39], v[28:31], v[244:247], v[36:39]
    v_mfma_f32_16x16x32_bf16 v[40:43], v[28:31], v[248:251], v[40:43]
    v_mfma_f32_16x16x32_bf16 v[44:47], v[28:31], v[252:255], v[44:47]
    s_nop 5
    v_mov_b32 v16, v32
    v_mov_b32 v17, v36
    v_mov_b32 v18, v40
    v_mov_b32 v19, v44
    ds_write_b128 v7, v[16:19] offset:38912
    s_waitcnt lgkmcnt(0)
    s_barrier
    s_cmp_lg_u32 s35, 0
    s_cbranch_scc1 L_end
    s_cmp_lt_i32 s34, 0
    s_cbranch_scc1 L_sv_fin
    s_mul_i32 s48, s4, 57344
    s_add_u32 s48, s48, 1245184
    s_add_u32 s48, s48, s98
    s_add_u32 s44, s32, s48
    s_addc_u32 s45, s33, 0
    s_mov_b32 s46, 50176
    s_mov_b32 s47, 0x20000
    v_lshrrev_b32 v6, 2, v0
    v_mul_u32_u24 v6, 1792, v6
    v_and_b32 v7, 3, v0
    v_lshl_add_u32 v6, v7, 4, v6
    s_lshl_b32 s48, s34, 6
    s_add_u32 s49, s48, 28672
    v_lshl_add_u32 v8, v7, 4, s48
    ds_read_b128 v[40:43], v8 offset:36864
    s_mov_b32 s36, s28
    s_mov_b32 s37, s29
    s_mov_b32 s38, 7168
    s_mov_b32 s39, 0x20000
    s_mov_b32 s51, 40000
L_sv_fppoll:
    buffer_load_dwordx4 v[16:19], v6, s[44:47], s48 offen sc1
    buffer_load_dwordx4 v[20:23], v6, s[44:47], s49 offen sc1
    s_waitcnt vmcnt(0)
    v_pk_add_f32 v[16:17], v[16:17], v[20:21]
    v_pk_add_f32 v[18:19], v[18:19], v[22:23]
    v_pk_add_f32 v[20:21], v[16:17], v[18:19]
    v_cmp_u_f32 vcc, v20, v21
    s_cbranch_vccz L_sv_fpok
    s_sub_u32 s51, s51, 1
    s_cmp_lg_u32 s51, 0
    s_cbranch_scc1 L_sv_fppoll
L_sv_fpok:
    s_nop 1
    v_add_f32_dpp v16, v16, v16 row_ror:4 row_mask:0xf bank_mask:0xf
    v_add_f32_dpp v17, v17, v17 row_ror:4 row_mask:0xf bank_mask:0xf
    v_add_f32_dpp v18, v18, v18 row_ror:4 row_mask:0xf bank_mask:0xf
    v_add_f32_dpp v19, v19, v19 row_ror:4 row_mask:0xf bank_mask:0xf
    s_nop 1
    v_add_f32_dpp v16, v16, v16 row_ror:8 row_mask:0xf bank_mask:0xf
    v_add_f32_dpp v17, v17, v17 row_ror:8 row_mask:0xf bank_mask:0xf
    v_add_f32_dpp v18, v18, v18 row_ror:8 row_mask:0xf bank_mask:0xf
    v_add_f32_dpp v19, v19, v19 row_ror:8 row_mask:0xf bank_mask:0xf
    v_mov_b32 v20, v16
    v_mov_b32 v21, v17
    v_mov_b32 v22, v18
    v_mov_b32 v23, v19
    s_nop 1
    v_permlane16_swap_b32 v16, v20
    v_permlane16_swap_b32 v17, v21
    v_permlane16_swap_b32 v18, v22
    v_permlane16_swap_b32 v19, v23
    s_nop 1
    v_add_f32 v16, v16, v20
    v_add_f32 v17, v17, v21
    v_add_f32 v18, v18, v22
    v_add_f32 v19, v19, v23
    v_mov_b32 v20, v16
    v_mov_b32 v21, v17
    v_mov_b32 v22, v18
    v_mov_b32 v23, v19
    s_nop 1
    v_permlane32_swap_b32 v16, v20
    v_permlane32_swap_b32 v17, v21
    v_permlane32_swap_b32 v18, v22
    v_permlane32_swap_b32 v19, v23
    s_nop 1
    v_add_f32 v16, v16, v20
    v_add_f32 v17, v17, v21
    v_add_f32 v18, v18, v22
    v_add_f32 v19, v19, v23
    v_cvt_pk_bf16_f32 v20, v16, v17
    v_cvt_pk_bf16_f32 v21, v18, v19
    v_lshlrev_b32 v16, 16, v20
    v_and_b32 v17, 0xffff0000, v20
    v_lshlrev_b32 v32, 16, v60
    v_and_b32 v33, 0xffff0000, v60
    v_lshlrev_b32 v18, 16, v21
    v_and_b32 v19, 0xffff0000, v21
    v_lshlrev_b32 v34, 16, v61
    v_and_b32 v35, 0xffff0000, v61
    v_add_f32 v16, v16, v32
    v_add_f32 v17, v17, v33
    v_add_f32 v18, v18, v34
    v_add_f32 v19, v19, v35
    v_cvt_pk_bf16_f32 v20, v16, v17
    v_cvt_pk_bf16_f32 v21, v18, v19
    v_lshlrev_b32 v16, 16, v20
    v_and_b32 v17, 0xffff0000, v20
    v_lshlrev_b32 v18, 16, v21
    v_and_b32 v19, 0xffff0000, v21
    s_waitcnt lgkmcnt(0)
    v_add_f32 v16, v16, v40
    v_add_f32 v17, v17, v41
    v_add_f32 v18, v18, v42
    v_add_f32 v19, v19, v43
    v_cvt_pk_bf16_f32 v20, v16, v17
    v_cvt_pk_bf16_f32 v21, v18, v19
    v_lshlrev_b32 v7, 3, v7
    s_mul_i32 s48, s4, 896
    s_lshl_b32 s49, s34, 5
    s_add_u32 s48, s48, s49
    s_mov_b64 exec, 0xf
    buffer_store_dwordx2 v[20:21], v7, s[36:39], s48 offen
    s_mov_b64 exec, -1
L_sv_fin:
L_end:
    s_endpgm
.section .rodata,"a"
.p2align 6
.amdhsa_kernel sequential_preLN__gqa_block_cached__dense_activation_squared_relu__decode_kernel
  .amdhsa_next_free_vgpr 256
  .amdhsa_next_free_sgpr 102
  .amdhsa_accum_offset 256
  .amdhsa_group_segment_fixed_size 0
  .amdhsa_kernarg_size 104
  .amdhsa_user_sgpr_count 2
  .amdhsa_user_sgpr_kernarg_segment_ptr 1
  .amdhsa_system_sgpr_workgroup_id_x 1
  .amdhsa_float_denorm_mode_32 3
.end_amdhsa_kernel
```
